```python
import torch

def _softmax(x, axis=-1):
    return torch.softmax(x, dim=axis)
def _gelu(x):
    return torch.nn.functional.gelu(x, approximate="tanh")
def _silu(x):
    return torch.nn.functional.silu(x)
def _sigmoid(x):
    return torch.sigmoid(x)
def _layernorm(x, axis=-1, eps=1e-5):
    m = x.mean(dim=axis, keepdim=True)
    v = x.var(dim=axis, keepdim=True, unbiased=False)
    return (x - m) / torch.sqrt(v + eps)
def _scatter_add(tgt, idx, src, axis=0):
    return tgt.clone().index_add_(axis, idx, src)
def _segment_sum(src, seg, n):
    out = torch.zeros((n,) + src.shape[1:], dtype=src.dtype)
    return out.index_add_(0, seg, src)
def _pad(x, pw):
    flat = tuple(v for pair in reversed(pw) for v in pair)
    return torch.nn.functional.pad(x, flat)

kernel_name = 'gated_mix__mha_block_cached__swiglu_ffn__decode'

def setup_inputs():

    _w = (lambda a: (lambda t: t.to(torch.bfloat16) if t.is_floating_point() else t)(torch.as_tensor(a)))
    def _A_setup():
        B, Sq, D = 8, 1, 448
        H, Sk, Dh = 16, 4096, 256
        return {
            "x": _w((lambda *s: torch.randn(*s, dtype=torch.bfloat16) * 0.05)(B, Sq, D)),
            "k_cache": _w((lambda *s: torch.randn(*s, dtype=torch.bfloat16) * 6.4)(B, H, Sk, Dh)),
            "v_cache": _w((lambda *s: torch.randn(*s, dtype=torch.bfloat16) * 0.2)(B, H, Sk, Dh)),
            "wq": _w((lambda *s: torch.randn(*s, dtype=torch.bfloat16) * 6.4)(D, H * Dh) * (D ** -0.5)),
            "wo": _w((lambda *s: torch.randn(*s, dtype=torch.bfloat16) * 0.2)(H * Dh, D) * ((H * Dh) ** -0.5)),
        }
    _A_in = _A_setup()

    def _B_setup():
        B, S, D, F = 8, 1, 448, 1792
        return {
            "x": _w((lambda *s: torch.randn(*s, dtype=torch.bfloat16) * 0.05)(B, S, D)),
            "w_gate": _w((lambda *s: torch.randn(*s, dtype=torch.bfloat16) * 0.05)(D, F)),
            "w_up": _w((lambda *s: torch.randn(*s, dtype=torch.bfloat16) * 0.05)(D, F)),
            "w_down": _w((lambda *s: torch.randn(*s, dtype=torch.bfloat16) * 0.05)(F, D)),
        }
    _B_in = _B_setup()

    return {
        "A_x": _A_in["x"],
        "A_k_cache": _A_in["k_cache"],
        "A_v_cache": _A_in["v_cache"],
        "A_wq": _A_in["wq"],
        "A_wo": _A_in["wo"],
        "B_x": _B_in["x"],
        "B_w_gate": _B_in["w_gate"],
        "B_w_up": _B_in["w_up"],
        "B_w_down": _B_in["w_down"],
        "gate_w": _w((lambda *s: torch.randn(*s, dtype=torch.bfloat16) * 0.05)(448) * 16.0),
    }

def reference(A_x, A_k_cache, A_v_cache, A_wq, A_wo, B_x, B_w_gate, B_w_up, B_w_down, gate_w):
    def _A_ref(x, k_cache, v_cache, wq, wo):
        B, Sq, D = x.shape
        H, Dh = 16, 256
        q = (lambda x, *d: x.permute(*d))((x @ wq).reshape(B, Sq, H, Dh), 0, 2, 1, 3)
        scores = torch.einsum("bhqd,bhkd->bhqk", q, k_cache) * (Dh ** -0.5)
        p = _softmax(scores, axis=-1)
        o = torch.einsum("bhqk,bhkd->bhqd", p, v_cache)
        return (lambda x, *d: x.permute(*d))(o, 0, 2, 1, 3).reshape(B, Sq, H * Dh) @ wo

    def _B_ref(x, w_gate, w_up, w_down):
        g = _silu(x @ w_gate)
        u = x @ w_up
        return (g * u) @ w_down

    x = A_x
    g = _sigmoid((x * gate_w).sum(-1, keepdims=True))
    a = _A_ref(x, A_k_cache, A_v_cache, A_wq, A_wo)
    b = _B_ref(x, B_w_gate, B_w_up, B_w_down)
    return g * a + (1 - g) * b
```

```asm
; @launch grid=(256,1,1) block=(448,1,1) lds=8192
.amdgcn_target "amdgcn-amd-amdhsa--gfx950"
.text
.globl gated_mix__mha_block_cached__swiglu_ffn__decode_kernel
.p2align 8
.type gated_mix__mha_block_cached__swiglu_ffn__decode_kernel,@function
gated_mix__mha_block_cached__swiglu_ffn__decode_kernel:
  s_cmp_ge_u32 s2, 256
  s_cbranch_scc1 L_end
  s_load_dwordx16 s[8:23], s[0:1], 0
  s_load_dwordx8 s[24:31], s[0:1], 64
  s_load_dwordx2 s[32:33], s[0:1], 96
  v_lshrrev_b32 v1, 6, v0
  v_and_b32 v0, 63, v0
  v_readfirstlane_b32 s3, v1
  s_bfe_u32 s35, s2, 0x40001
  s_and_b32 s36, s2, 1
  s_lshr_b32 s34, s2, 5
  s_and_b32 s37, s2, 31
  s_lshl_b32 s39, s34, 1
  s_or_b32 s39, s39, s36
  s_cmp_ge_u32 s3, 4
  s_cbranch_scc1 L_helper
  s_setprio 3
  v_lshlrev_b32 v1, 4, v0
  s_mul_i32 s56, s3, 1024
  s_mov_b32 s58, s56
  s_lshl_b32 s57, s2, 20
  s_waitcnt lgkmcnt(0)
  s_add_u32 s40, s10, s57
  s_addc_u32 s41, s11, 0
  s_mov_b32 s42, 1048576
  s_mov_b32 s43, 0x20000
  buffer_load_dwordx4 v[168:171], v1, s[40:43], s56 offen nt
  s_add_u32 s56, s56, 4096
  buffer_load_dwordx4 v[172:175], v1, s[40:43], s56 offen nt
  s_add_u32 s56, s56, 4096
  buffer_load_dwordx4 v[176:179], v1, s[40:43], s56 offen nt
  s_add_u32 s56, s56, 4096
  buffer_load_dwordx4 v[180:183], v1, s[40:43], s56 offen nt
  s_add_u32 s56, s56, 4096
  buffer_load_dwordx4 v[184:187], v1, s[40:43], s56 offen nt
  s_add_u32 s56, s56, 4096
  buffer_load_dwordx4 v[188:191], v1, s[40:43], s56 offen nt
  s_add_u32 s56, s56, 4096
  s_add_u32 s44, s12, s57
  s_addc_u32 s45, s13, 0
  s_mov_b32 s46, 1048576
  s_mov_b32 s47, 0x20000
  s_add_u32 s32, s32, 0x3fc00000
  s_addc_u32 s33, s33, 0
  s_lshl_b32 s59, s35, 13
  s_lshl_b32 s60, s39, 9
  s_add_u32 s59, s59, s60
  s_add_u32 s59, s59, 131072
  s_add_u32 s48, s32, s59
  s_addc_u32 s49, s33, 0
  s_mov_b32 s50, 512
  s_mov_b32 s51, 0x20000
  v_lshrrev_b32 v18, 5, v0
  v_mul_u32_u24 v18, 0x202, v18
  v_add_u32 v18, 0x100, v18
  v_or_b32 v19, 0xc0c0000, v18
  v_lshlrev_b32 v20, 16, v18
  v_or_b32 v20, 0xc0c, v20
  v_and_b32 v21, 1, v0
  v_cmp_eq_u32 vcc, 1, v21
  s_nop 1
  v_cndmask_b32 v19, v19, v20, vcc
  v_lshrrev_b32 v20, 1, v0
  v_xor_b32 v21, v0, v20
  v_and_b32 v21, 8, v21
  v_and_b32 v20, 3, v20
  v_or_b32 v20, v20, v21
  v_mov_b32 v21, 0xc0c0c0c
  v_cmp_eq_u32 vcc, 0, v20
  s_nop 1
  v_cndmask_b32 v6, v21, v19, vcc
  v_cmp_eq_u32 vcc, 1, v20
  s_nop 1
  v_cndmask_b32 v7, v21, v19, vcc
  v_cmp_eq_u32 vcc, 2, v20
  s_nop 1
  v_cndmask_b32 v8, v21, v19, vcc
  v_cmp_eq_u32 vcc, 3, v20
  s_nop 1
  v_cndmask_b32 v9, v21, v19, vcc
  v_and_b32 v35, 31, v0
  v_lshlrev_b32 v35, 4, v35
  v_mov_b32 v34, 0xff800000
  s_mov_b32 s60, 0xcccccccc
  s_mov_b32 s61, 0xcccccccc
  s_mov_b32 s62, 0xaaaaaaaa
  s_mov_b32 s63, 0xaaaaaaaa
  v_lshrrev_b32 v39, 5, v0
  v_lshlrev_b32 v39, 8, v39
  v_and_b32 v38, 15, v0
  v_lshlrev_b32 v38, 4, v38
  v_add_u32 v39, v39, v38
  v_bfe_u32 v38, v0, 4, 1
  v_lshlrev_b32 v38, 3, v38
  v_add_u32 v39, v39, v38
  s_lshl_b32 s59, s3, 10
  v_add_u32 v38, s59, v1
  s_waitcnt vmcnt(5)
  buffer_load_dwordx4 v[192:195], v1, s[40:43], s56 offen nt
  s_add_u32 s56, s56, 4096
  s_waitcnt vmcnt(5)
  buffer_load_dwordx4 v[196:199], v1, s[40:43], s56 offen nt
  s_add_u32 s56, s56, 4096
  s_waitcnt vmcnt(5)
  buffer_load_dwordx4 v[200:203], v1, s[40:43], s56 offen nt
  s_add_u32 s56, s56, 4096
  s_waitcnt vmcnt(5)
  buffer_load_dwordx4 v[204:207], v1, s[40:43], s56 offen nt
  s_add_u32 s56, s56, 4096
  s_waitcnt vmcnt(5)
  buffer_load_dwordx4 v[208:211], v1, s[40:43], s56 offen nt
  s_add_u32 s56, s56, 4096
  s_waitcnt vmcnt(5)
  buffer_load_dwordx4 v[212:215], v1, s[40:43], s56 offen nt
  s_add_u32 s56, s56, 4096
  s_waitcnt vmcnt(5)
  buffer_load_dwordx4 v[216:219], v1, s[40:43], s56 offen nt
  s_add_u32 s56, s56, 4096
  s_waitcnt vmcnt(5)
  buffer_load_dwordx4 v[220:223], v1, s[40:43], s56 offen nt
  s_add_u32 s56, s56, 4096
  s_waitcnt vmcnt(5)
  buffer_load_dwordx4 v[224:227], v1, s[40:43], s56 offen nt
  s_add_u32 s56, s56, 4096
  s_waitcnt vmcnt(5)
  buffer_load_dwordx4 v[228:231], v1, s[40:43], s56 offen nt
  s_add_u32 s56, s56, 4096
  s_waitcnt vmcnt(5)
  buffer_load_dwordx4 v[232:235], v1, s[40:43], s56 offen nt
  s_add_u32 s56, s56, 4096
  s_waitcnt vmcnt(5)
  buffer_load_dwordx4 v[236:239], v1, s[40:43], s56 offen nt
  s_add_u32 s56, s56, 4096
  s_waitcnt vmcnt(5)
  buffer_load_dwordx4 v[240:243], v1, s[40:43], s56 offen nt
  s_add_u32 s56, s56, 4096
  s_waitcnt vmcnt(5)
  buffer_load_dwordx4 v[244:247], v1, s[40:43], s56 offen nt
  s_add_u32 s56, s56, 4096
  s_waitcnt vmcnt(5)
  buffer_load_dwordx4 v[248:251], v1, s[40:43], s56 offen nt
  s_add_u32 s56, s56, 4096
  s_waitcnt vmcnt(5)
  buffer_load_dwordx4 v[252:255], v1, s[40:43], s56 offen nt
  s_add_u32 s56, s56, 4096
  s_waitcnt vmcnt(5)
  buffer_load_dwordx4 v[128:131], v1, s[40:43], s56 offen nt
  s_add_u32 s56, s56, 4096
  s_waitcnt vmcnt(5)
  buffer_load_dwordx4 v[132:135], v1, s[40:43], s56 offen nt
  s_add_u32 s56, s56, 4096
  s_waitcnt vmcnt(5)
  buffer_load_dwordx4 v[136:139], v1, s[40:43], s56 offen nt
  s_add_u32 s56, s56, 4096
  s_waitcnt vmcnt(5)
  buffer_load_dwordx4 v[140:143], v1, s[40:43], s56 offen nt
  s_add_u32 s56, s56, 4096
  s_waitcnt vmcnt(5)
  buffer_load_dwordx4 v[144:147], v1, s[40:43], s56 offen nt
  s_add_u32 s56, s56, 4096
  s_waitcnt vmcnt(5)
  buffer_load_dwordx4 v[148:151], v1, s[40:43], s56 offen nt
  s_add_u32 s56, s56, 4096
  s_waitcnt vmcnt(5)
  buffer_load_dwordx4 v[152:155], v1, s[40:43], s56 offen nt
  s_add_u32 s56, s56, 4096
  s_waitcnt vmcnt(5)
  buffer_load_dwordx4 v[156:159], v1, s[40:43], s56 offen nt
  s_add_u32 s56, s56, 4096
  ds_write_b32 v38, v34 offset:512
  s_waitcnt vmcnt(5)
  buffer_load_dwordx4 v[160:163], v1, s[40:43], s56 offen nt
  s_add_u32 s56, s56, 4096
  s_waitcnt vmcnt(5)
  buffer_load_dwordx4 v[164:167], v1, s[40:43], s56 offen nt
  s_add_u32 s56, s56, 4096
  s_waitcnt vmcnt(5)
  buffer_load_dwordx4 v[40:43], v1, s[40:43], s56 offen nt
  s_add_u32 s56, s56, 4096
  s_waitcnt vmcnt(5)
  buffer_load_dwordx4 v[44:47], v1, s[40:43], s56 offen nt
  s_add_u32 s56, s56, 4096
  s_waitcnt vmcnt(5)
  buffer_load_dwordx4 v[48:51], v1, s[40:43], s56 offen nt
  s_add_u32 s56, s56, 4096
  s_waitcnt vmcnt(5)
  buffer_load_dwordx4 v[52:55], v1, s[40:43], s56 offen nt
  s_add_u32 s56, s56, 4096
  s_waitcnt vmcnt(5)
  buffer_load_dwordx4 v[56:59], v1, s[40:43], s56 offen nt
  s_add_u32 s56, s56, 4096
  s_waitcnt vmcnt(5)
  buffer_load_dwordx4 v[60:63], v1, s[40:43], s56 offen nt
  s_add_u32 s56, s56, 4096
  s_waitcnt vmcnt(5)
  buffer_load_dwordx4 v[64:67], v1, s[40:43], s56 offen nt
  s_add_u32 s56, s56, 4096
  s_waitcnt vmcnt(5)
  buffer_load_dwordx4 v[68:71], v1, s[40:43], s56 offen nt
  s_add_u32 s56, s56, 4096
  s_waitcnt vmcnt(5)
  buffer_load_dwordx4 v[72:75], v1, s[40:43], s56 offen nt
  s_add_u32 s56, s56, 4096
  s_waitcnt vmcnt(5)
  buffer_load_dwordx4 v[76:79], v1, s[40:43], s56 offen nt
  s_add_u32 s56, s56, 4096
  s_waitcnt vmcnt(5)
  buffer_load_dwordx4 v[80:83], v1, s[40:43], s56 offen nt
  s_add_u32 s56, s56, 4096
  s_waitcnt vmcnt(5)
  buffer_load_dwordx4 v[84:87], v1, s[40:43], s56 offen nt
  s_add_u32 s56, s56, 4096
  s_waitcnt vmcnt(5)
  buffer_load_dwordx4 v[88:91], v1, s[40:43], s56 offen nt
  s_add_u32 s56, s56, 4096
  s_waitcnt vmcnt(5)
  buffer_load_dwordx4 v[92:95], v1, s[40:43], s56 offen nt
  s_add_u32 s56, s56, 4096
  s_waitcnt vmcnt(5)
  buffer_load_dwordx4 v[96:99], v1, s[40:43], s56 offen nt
  s_add_u32 s56, s56, 4096
  s_waitcnt vmcnt(5)
  buffer_load_dwordx4 v[100:103], v1, s[40:43], s56 offen nt
  s_add_u32 s56, s56, 4096
  s_waitcnt vmcnt(5)
  buffer_load_dwordx4 v[104:107], v1, s[40:43], s56 offen nt
  s_add_u32 s56, s56, 4096
  s_waitcnt vmcnt(5)
  buffer_load_dwordx4 v[108:111], v1, s[40:43], s56 offen nt
  s_add_u32 s56, s56, 4096
  s_waitcnt vmcnt(5)
  buffer_load_dwordx4 v[112:115], v1, s[40:43], s56 offen nt
  s_add_u32 s56, s56, 4096
  s_waitcnt vmcnt(5)
  buffer_load_dwordx4 v[116:119], v1, s[40:43], s56 offen nt
  s_add_u32 s56, s56, 4096
  s_waitcnt vmcnt(5)
  buffer_load_dwordx4 v[120:123], v1, s[40:43], s56 offen nt
  s_add_u32 s56, s56, 4096
  s_waitcnt vmcnt(5)
  buffer_load_dwordx4 v[124:127], v1, s[40:43], s56 offen nt
  s_add_u32 s56, s56, 4096
  s_barrier
  ds_read_b128 v[2:5], v35 offset:0
  s_lshl_b32 s59, s3, 2
  v_mov_b32 v35, s59
  s_mov_b64 vcc, 0
  s_waitcnt lgkmcnt(0)
  v_dot2_f32_bf16 v18, v168, v2, 0
  v_dot2_f32_bf16 v18, v169, v3, v18
  v_dot2_f32_bf16 v18, v170, v4, v18
  v_dot2_f32_bf16 v18, v171, v5, v18
  s_cbranch_vccnz L_em1
  s_waitcnt vmcnt(3)
L_em1:
  s_waitcnt vmcnt(5)
  buffer_load_dwordx4 v[168:171], v1, s[40:43], s56 offen nt
  s_add_u32 s56, s56, 4096
  v_dot2_f32_bf16 v19, v172, v2, 0
  v_dot2_f32_bf16 v19, v173, v3, v19
  v_dot2_f32_bf16 v19, v174, v4, v19
  v_dot2_f32_bf16 v19, v175, v5, v19
  v_dot2_f32_bf16 v20, v176, v2, 0
  s_nop 1
  v_permlane16_swap_b32 v18, v19
  v_dot2_f32_bf16 v20, v177, v3, v20
  v_dot2_f32_bf16 v20, v178, v4, v20
  v_add_f32 v18, v18, v19
  v_dot2_f32_bf16 v20, v179, v5, v20
  v_dot2_f32_bf16 v21, v180, v2, 0
  v_add_f32_dpp v22, v18, v18 row_ror:8 row_mask:0xf bank_mask:0xf
  v_dot2_f32_bf16 v21, v181, v3, v21
  v_dot2_f32_bf16 v21, v182, v4, v21
  v_dot2_f32_bf16 v21, v183, v5, v21
  v_dot2_f32_bf16 v18, v184, v2, 0
  s_nop 1
  v_permlane16_swap_b32 v20, v21
  v_dot2_f32_bf16 v18, v185, v3, v18
  v_dot2_f32_bf16 v18, v186, v4, v18
  v_add_f32 v20, v20, v21
  v_dot2_f32_bf16 v18, v187, v5, v18
  v_dot2_f32_bf16 v19, v188, v2, 0
  v_add_f32_dpp v22, v20, v20 row_ror:8 row_mask:0xf bank_mask:0xc
  v_dot2_f32_bf16 v19, v189, v3, v19
  v_dot2_f32_bf16 v19, v190, v4, v19
  v_add_f32_dpp v23, v22, v22 row_half_mirror row_mask:0xf bank_mask:0xf
  v_dot2_f32_bf16 v19, v191, v5, v19
  v_dot2_f32_bf16 v20, v192, v2, 0
  s_nop 1
  v_permlane16_swap_b32 v18, v19
  v_dot2_f32_bf16 v20, v193, v3, v20
  v_dot2_f32_bf16 v20, v194, v4, v20
  v_add_f32 v18, v18, v19
  v_dot2_f32_bf16 v20, v195, v5, v20
  v_dot2_f32_bf16 v21, v196, v2, 0
  v_add_f32_dpp v22, v18, v18 row_ror:8 row_mask:0xf bank_mask:0xf
  v_dot2_f32_bf16 v21, v197, v3, v21
  v_dot2_f32_bf16 v21, v198, v4, v21
  v_dot2_f32_bf16 v21, v199, v5, v21
  v_dot2_f32_bf16 v18, v200, v2, 0
  s_nop 1
  v_permlane16_swap_b32 v20, v21
  v_dot2_f32_bf16 v18, v201, v3, v18
  v_dot2_f32_bf16 v18, v202, v4, v18
  v_add_f32 v20, v20, v21
  v_dot2_f32_bf16 v18, v203, v5, v18
  v_dot2_f32_bf16 v19, v204, v2, 0
  v_add_f32_dpp v22, v20, v20 row_ror:8 row_mask:0xf bank_mask:0xc
  v_dot2_f32_bf16 v19, v205, v3, v19
  v_dot2_f32_bf16 v19, v206, v4, v19
  v_add_f32_dpp v23, v22, v22 row_half_mirror row_mask:0xf bank_mask:0xa
  v_dot2_f32_bf16 v19, v207, v5, v19
  s_cbranch_vccnz L_em2
  s_waitcnt vmcnt(3)
L_em2:
  s_waitcnt vmcnt(5)
  buffer_load_dwordx4 v[172:175], v1, s[40:43], s56 offen nt
  s_add_u32 s56, s56, 4096
  v_dot2_f32_bf16 v20, v208, v2, 0
  v_add_f32_dpp v24, v23, v23 quad_perm:[2,3,0,1] row_mask:0xf bank_mask:0xf
  v_dot2_f32_bf16 v20, v209, v3, v20
  v_dot2_f32_bf16 v20, v210, v4, v20
  v_permlane16_swap_b32 v18, v19
  v_dot2_f32_bf16 v20, v211, v5, v20
  v_dot2_f32_bf16 v21, v212, v2, 0
  v_add_f32 v18, v18, v19
  v_dot2_f32_bf16 v21, v213, v3, v21
  v_dot2_f32_bf16 v21, v214, v4, v21
  v_add_f32_dpp v22, v18, v18 row_ror:8 row_mask:0xf bank_mask:0xf
  v_dot2_f32_bf16 v21, v215, v5, v21
  v_dot2_f32_bf16 v18, v216, v2, 0
  s_nop 1
  v_permlane16_swap_b32 v20, v21
  v_dot2_f32_bf16 v18, v217, v3, v18
  v_dot2_f32_bf16 v18, v218, v4, v18
  v_add_f32 v20, v20, v21
  v_dot2_f32_bf16 v18, v219, v5, v18
  v_dot2_f32_bf16 v19, v220, v2, 0
  v_add_f32_dpp v22, v20, v20 row_ror:8 row_mask:0xf bank_mask:0xc
  v_dot2_f32_bf16 v19, v221, v3, v19
  v_dot2_f32_bf16 v19, v222, v4, v19
  v_add_f32_dpp v23, v22, v22 row_half_mirror row_mask:0xf bank_mask:0xf
  v_dot2_f32_bf16 v19, v223, v5, v19
  v_dot2_f32_bf16 v20, v224, v2, 0
  s_nop 1
  v_permlane16_swap_b32 v18, v19
  v_dot2_f32_bf16 v20, v225, v3, v20
  v_dot2_f32_bf16 v20, v226, v4, v20
  v_add_f32 v18, v18, v19
  v_dot2_f32_bf16 v20, v227, v5, v20
  v_dot2_f32_bf16 v21, v228, v2, 0
  v_add_f32_dpp v22, v18, v18 row_ror:8 row_mask:0xf bank_mask:0xf
  v_dot2_f32_bf16 v21, v229, v3, v21
  v_dot2_f32_bf16 v21, v230, v4, v21
  v_dot2_f32_bf16 v21, v231, v5, v21
  v_dot2_f32_bf16 v18, v232, v2, 0
  s_nop 1
  v_permlane16_swap_b32 v20, v21
  v_dot2_f32_bf16 v18, v233, v3, v18
  v_dot2_f32_bf16 v18, v234, v4, v18
  v_add_f32 v20, v20, v21
  v_dot2_f32_bf16 v18, v235, v5, v18
  v_dot2_f32_bf16 v19, v236, v2, 0
  v_add_f32_dpp v22, v20, v20 row_ror:8 row_mask:0xf bank_mask:0xc
  v_dot2_f32_bf16 v19, v237, v3, v19
  v_dot2_f32_bf16 v19, v238, v4, v19
  v_add_f32_dpp v23, v22, v22 row_half_mirror row_mask:0xf bank_mask:0xa
  v_dot2_f32_bf16 v19, v239, v5, v19
  v_dot2_f32_bf16 v20, v240, v2, 0
  v_add_f32_dpp v25, v23, v23 quad_perm:[2,3,0,1] row_mask:0xf bank_mask:0xf
  v_dot2_f32_bf16 v20, v241, v3, v20
  v_dot2_f32_bf16 v20, v242, v4, v20
  v_cndmask_b32 v24, v24, v25, s[60:61]
  v_dot2_f32_bf16 v20, v243, v5, v20
  s_cbranch_vccnz L_em3
  s_waitcnt vmcnt(3)
L_em3:
  s_waitcnt vmcnt(5)
  buffer_load_dwordx4 v[176:179], v1, s[40:43], s56 offen nt
  s_add_u32 s56, s56, 4096
  v_dot2_f32_bf16 v21, v244, v2, 0
  v_add_f32_dpp v26, v24, v24 quad_perm:[1,0,3,2] row_mask:0xf bank_mask:0xf
  v_dot2_f32_bf16 v21, v245, v3, v21
  v_dot2_f32_bf16 v21, v246, v4, v21
  v_permlane16_swap_b32 v18, v19
  v_dot2_f32_bf16 v21, v247, v5, v21
  v_add_f32 v18, v18, v19
  s_nop 1
  v_add_f32_dpp v22, v18, v18 row_ror:8 row_mask:0xf bank_mask:0xf
  v_dot2_f32_bf16 v18, v248, v2, 0
  v_permlane16_swap_b32 v20, v21
  v_dot2_f32_bf16 v18, v249, v3, v18
  v_dot2_f32_bf16 v18, v250, v4, v18
  v_add_f32 v20, v20, v21
  v_dot2_f32_bf16 v18, v251, v5, v18
  v_dot2_f32_bf16 v19, v252, v2, 0
  v_add_f32_dpp v22, v20, v20 row_ror:8 row_mask:0xf bank_mask:0xc
  v_dot2_f32_bf16 v19, v253, v3, v19
  v_dot2_f32_bf16 v19, v254, v4, v19
  v_add_f32_dpp v23, v22, v22 row_half_mirror row_mask:0xf bank_mask:0xf
  v_dot2_f32_bf16 v19, v255, v5, v19
  v_dot2_f32_bf16 v20, v128, v2, 0
  s_nop 1
  v_permlane16_swap_b32 v18, v19
  v_dot2_f32_bf16 v20, v129, v3, v20
  v_dot2_f32_bf16 v20, v130, v4, v20
  v_add_f32 v18, v18, v19
  v_dot2_f32_bf16 v20, v131, v5, v20
  v_dot2_f32_bf16 v21, v132, v2, 0
  v_add_f32_dpp v22, v18, v18 row_ror:8 row_mask:0xf bank_mask:0xf
  v_dot2_f32_bf16 v21, v133, v3, v21
  v_dot2_f32_bf16 v21, v134, v4, v21
  v_dot2_f32_bf16 v21, v135, v5, v21
  v_dot2_f32_bf16 v18, v136, v2, 0
  s_nop 1
  v_permlane16_swap_b32 v20, v21
  v_dot2_f32_bf16 v18, v137, v3, v18
  v_dot2_f32_bf16 v18, v138, v4, v18
  v_add_f32 v20, v20, v21
  v_dot2_f32_bf16 v18, v139, v5, v18
  v_dot2_f32_bf16 v19, v140, v2, 0
  v_add_f32_dpp v22, v20, v20 row_ror:8 row_mask:0xf bank_mask:0xc
  v_dot2_f32_bf16 v19, v141, v3, v19
  v_dot2_f32_bf16 v19, v142, v4, v19
  v_add_f32_dpp v23, v22, v22 row_half_mirror row_mask:0xf bank_mask:0xa
  v_dot2_f32_bf16 v19, v143, v5, v19
  v_dot2_f32_bf16 v20, v144, v2, 0
  v_add_f32_dpp v24, v23, v23 quad_perm:[2,3,0,1] row_mask:0xf bank_mask:0xf
  v_dot2_f32_bf16 v20, v145, v3, v20
  v_dot2_f32_bf16 v20, v146, v4, v20
  v_permlane16_swap_b32 v18, v19
  v_dot2_f32_bf16 v20, v147, v5, v20
  v_dot2_f32_bf16 v21, v148, v2, 0
  v_add_f32 v18, v18, v19
  v_dot2_f32_bf16 v21, v149, v3, v21
  v_dot2_f32_bf16 v21, v150, v4, v21
  v_add_f32_dpp v22, v18, v18 row_ror:8 row_mask:0xf bank_mask:0xf
  v_dot2_f32_bf16 v21, v151, v5, v21
  s_cbranch_vccnz L_em4
  s_waitcnt vmcnt(3)
L_em4:
  s_waitcnt vmcnt(5)
  buffer_load_dwordx4 v[180:183], v1, s[40:43], s56 offen nt
  s_add_u32 s56, s56, 4096
  v_dot2_f32_bf16 v18, v152, v2, 0
  v_permlane16_swap_b32 v20, v21
  v_dot2_f32_bf16 v18, v153, v3, v18
  v_dot2_f32_bf16 v18, v154, v4, v18
  v_add_f32 v20, v20, v21
  v_dot2_f32_bf16 v18, v155, v5, v18
  v_dot2_f32_bf16 v19, v156, v2, 0
  v_add_f32_dpp v22, v20, v20 row_ror:8 row_mask:0xf bank_mask:0xc
  v_dot2_f32_bf16 v19, v157, v3, v19
  v_dot2_f32_bf16 v19, v158, v4, v19
  v_add_f32_dpp v23, v22, v22 row_half_mirror row_mask:0xf bank_mask:0xf
  v_dot2_f32_bf16 v19, v159, v5, v19
  v_dot2_f32_bf16 v20, v160, v2, 0
  s_nop 1
  v_permlane16_swap_b32 v18, v19
  v_dot2_f32_bf16 v20, v161, v3, v20
  v_dot2_f32_bf16 v20, v162, v4, v20
  v_add_f32 v18, v18, v19
  v_dot2_f32_bf16 v20, v163, v5, v20
  v_dot2_f32_bf16 v21, v164, v2, 0
  v_add_f32_dpp v22, v18, v18 row_ror:8 row_mask:0xf bank_mask:0xf
  v_dot2_f32_bf16 v21, v165, v3, v21
  v_dot2_f32_bf16 v21, v166, v4, v21
  v_dot2_f32_bf16 v21, v167, v5, v21
  s_nop 2
  v_permlane16_swap_b32 v20, v21
  v_add_f32 v20, v20, v21
  s_nop 1
  v_add_f32_dpp v22, v20, v20 row_ror:8 row_mask:0xf bank_mask:0xc
  s_nop 1
  v_add_f32_dpp v23, v22, v22 row_half_mirror row_mask:0xf bank_mask:0xa
  s_nop 1
  v_add_f32_dpp v25, v23, v23 quad_perm:[2,3,0,1] row_mask:0xf bank_mask:0xf
  v_cndmask_b32 v24, v24, v25, s[60:61]
  s_nop 1
  v_add_f32_dpp v27, v24, v24 quad_perm:[1,0,3,2] row_mask:0xf bank_mask:0xf
  v_cndmask_b32 v26, v26, v27, s[62:63]
  v_cvt_pk_bf16_f32 v26, v26, v26
  v_lshlrev_b32 v17, 16, v26
  v_max_f32 v34, v34, v17
  v_mov_b32 v16, v17
  v_dot2_f32_bf16 v18, v40, v2, 0
  v_dot2_f32_bf16 v18, v41, v3, v18
  v_dot2_f32_bf16 v18, v42, v4, v18
  v_dot2_f32_bf16 v18, v43, v5, v18
  v_dot2_f32_bf16 v19, v44, v2, 0
  v_dot2_f32_bf16 v19, v45, v3, v19
  v_dot2_f32_bf16 v19, v46, v4, v19
  v_dot2_f32_bf16 v19, v47, v5, v19
  v_dot2_f32_bf16 v20, v48, v2, 0
  s_nop 1
  v_permlane16_swap_b32 v18, v19
  v_dot2_f32_bf16 v20, v49, v3, v20
  v_dot2_f32_bf16 v20, v50, v4, v20
  v_add_f32 v18, v18, v19
  v_dot2_f32_bf16 v20, v51, v5, v20
  ds_read_b32 v0, v35 offset:4688
  v_dot2_f32_bf16 v21, v52, v2, 0
  v_add_f32_dpp v22, v18, v18 row_ror:8 row_mask:0xf bank_mask:0xf
  v_dot2_f32_bf16 v21, v53, v3, v21
  v_dot2_f32_bf16 v21, v54, v4, v21
  v_dot2_f32_bf16 v21, v55, v5, v21
  v_dot2_f32_bf16 v18, v56, v2, 0
  s_nop 1
  v_permlane16_swap_b32 v20, v21
  v_dot2_f32_bf16 v18, v57, v3, v18
  v_dot2_f32_bf16 v18, v58, v4, v18
  v_add_f32 v20, v20, v21
  v_dot2_f32_bf16 v18, v59, v5, v18
  s_waitcnt lgkmcnt(0)
  v_cmp_le_i32 vcc, 32, v0
  s_cbranch_vccnz L_em5
  s_waitcnt vmcnt(3)
L_em5:
  s_waitcnt vmcnt(5)
  buffer_load_dwordx4 v[184:187], v1, s[40:43], s56 offen nt
  s_add_u32 s56, s56, 4096
  v_dot2_f32_bf16 v19, v60, v2, 0
  v_add_f32_dpp v22, v20, v20 row_ror:8 row_mask:0xf bank_mask:0xc
  v_dot2_f32_bf16 v19, v61, v3, v19
  v_dot2_f32_bf16 v19, v62, v4, v19
  v_add_f32_dpp v23, v22, v22 row_half_mirror row_mask:0xf bank_mask:0xf
  v_dot2_f32_bf16 v19, v63, v5, v19
  v_dot2_f32_bf16 v20, v64, v2, 0
  s_nop 1
  v_permlane16_swap_b32 v18, v19
  v_dot2_f32_bf16 v20, v65, v3, v20
  v_dot2_f32_bf16 v20, v66, v4, v20
  v_add_f32 v18, v18, v19
  v_dot2_f32_bf16 v20, v67, v5, v20
  ds_read_b32 v0, v35 offset:4688
  v_dot2_f32_bf16 v21, v68, v2, 0
  v_add_f32_dpp v22, v18, v18 row_ror:8 row_mask:0xf bank_mask:0xf
  v_dot2_f32_bf16 v21, v69, v3, v21
  v_dot2_f32_bf16 v21, v70, v4, v21
  v_dot2_f32_bf16 v21, v71, v5, v21
  v_dot2_f32_bf16 v18, v72, v2, 0
  s_nop 1
  v_permlane16_swap_b32 v20, v21
  v_dot2_f32_bf16 v18, v73, v3, v18
  v_dot2_f32_bf16 v18, v74, v4, v18
  v_add_f32 v20, v20, v21
  v_dot2_f32_bf16 v18, v75, v5, v18
  s_waitcnt lgkmcnt(0)
  v_cmp_le_i32 vcc, 48, v0
  v_dot2_f32_bf16 v19, v76, v2, 0
  v_add_f32_dpp v22, v20, v20 row_ror:8 row_mask:0xf bank_mask:0xc
  v_dot2_f32_bf16 v19, v77, v3, v19
  v_dot2_f32_bf16 v19, v78, v4, v19
  v_add_f32_dpp v23, v22, v22 row_half_mirror row_mask:0xf bank_mask:0xa
  v_dot2_f32_bf16 v19, v79, v5, v19
  v_dot2_f32_bf16 v20, v80, v2, 0
  v_add_f32_dpp v24, v23, v23 quad_perm:[2,3,0,1] row_mask:0xf bank_mask:0xf
  v_dot2_f32_bf16 v20, v81, v3, v20
  v_dot2_f32_bf16 v20, v82, v4, v20
  v_permlane16_swap_b32 v18, v19
  v_dot2_f32_bf16 v20, v83, v5, v20
  ds_read_b32 v0, v35 offset:4688
  v_dot2_f32_bf16 v21, v84, v2, 0
  v_add_f32 v18, v18, v19
  v_dot2_f32_bf16 v21, v85, v3, v21
  v_dot2_f32_bf16 v21, v86, v4, v21
  v_add_f32_dpp v22, v18, v18 row_ror:8 row_mask:0xf bank_mask:0xf
  v_dot2_f32_bf16 v21, v87, v5, v21
  v_dot2_f32_bf16 v18, v88, v2, 0
  s_nop 1
  v_permlane16_swap_b32 v20, v21
  v_dot2_f32_bf16 v18, v89, v3, v18
  v_dot2_f32_bf16 v18, v90, v4, v18
  v_add_f32 v20, v20, v21
  v_dot2_f32_bf16 v18, v91, v5, v18
  s_waitcnt lgkmcnt(0)
  v_cmp_le_i32 vcc, 40, v0
  v_dot2_f32_bf16 v19, v92, v2, 0
  v_add_f32_dpp v22, v20, v20 row_ror:8 row_mask:0xf bank_mask:0xc
  v_dot2_f32_bf16 v19, v93, v3, v19
  v_dot2_f32_bf16 v19, v94, v4, v19
  v_add_f32_dpp v23, v22, v22 row_half_mirror row_mask:0xf bank_mask:0xf
  v_dot2_f32_bf16 v19, v95, v5, v19
  s_cbranch_vccnz L_em6
  s_waitcnt vmcnt(3)
L_em6:
  s_waitcnt vmcnt(5)
  buffer_load_dwordx4 v[188:191], v1, s[40:43], s56 offen nt
  s_add_u32 s56, s56, 4096
  v_dot2_f32_bf16 v20, v96, v2, 0
  v_permlane16_swap_b32 v18, v19
  v_dot2_f32_bf16 v20, v97, v3, v20
  v_dot2_f32_bf16 v20, v98, v4, v20
  v_add_f32 v18, v18, v19
  v_dot2_f32_bf16 v20, v99, v5, v20
  ds_read_b32 v0, v35 offset:4688
  v_dot2_f32_bf16 v21, v100, v2, 0
  v_add_f32_dpp v22, v18, v18 row_ror:8 row_mask:0xf bank_mask:0xf
  v_dot2_f32_bf16 v21, v101, v3, v21
  v_dot2_f32_bf16 v21, v102, v4, v21
  v_dot2_f32_bf16 v21, v103, v5, v21
  v_dot2_f32_bf16 v18, v104, v2, 0
  s_nop 1
  v_permlane16_swap_b32 v20, v21
  v_dot2_f32_bf16 v18, v105, v3, v18
  v_dot2_f32_bf16 v18, v106, v4, v18
  v_add_f32 v20, v20, v21
  v_dot2_f32_bf16 v18, v107, v5, v18
  s_waitcnt lgkmcnt(0)
  v_cmp_le_i32 vcc, 56, v0
  v_dot2_f32_bf16 v19, v108, v2, 0
  v_add_f32_dpp v22, v20, v20 row_ror:8 row_mask:0xf bank_mask:0xc
  v_dot2_f32_bf16 v19, v109, v3, v19
  v_dot2_f32_bf16 v19, v110, v4, v19
  v_add_f32_dpp v23, v22, v22 row_half_mirror row_mask:0xf bank_mask:0xa
  v_dot2_f32_bf16 v19, v111, v5, v19
  v_dot2_f32_bf16 v20, v112, v2, 0
  v_add_f32_dpp v25, v23, v23 quad_perm:[2,3,0,1] row_mask:0xf bank_mask:0xf
  v_dot2_f32_bf16 v20, v113, v3, v20
  v_dot2_f32_bf16 v20, v114, v4, v20
  v_cndmask_b32 v24, v24, v25, s[60:61]
  v_dot2_f32_bf16 v20, v115, v5, v20
  ds_read_b32 v0, v35 offset:4688
  v_dot2_f32_bf16 v21, v116, v2, 0
  v_add_f32_dpp v26, v24, v24 quad_perm:[1,0,3,2] row_mask:0xf bank_mask:0xf
  v_dot2_f32_bf16 v21, v117, v3, v21
  v_dot2_f32_bf16 v21, v118, v4, v21
  v_permlane16_swap_b32 v18, v19
  v_dot2_f32_bf16 v21, v119, v5, v21
  v_add_f32 v18, v18, v19
  s_nop 1
  v_add_f32_dpp v22, v18, v18 row_ror:8 row_mask:0xf bank_mask:0xf
  v_dot2_f32_bf16 v18, v120, v2, 0
  v_permlane16_swap_b32 v20, v21
  v_dot2_f32_bf16 v18, v121, v3, v18
  v_dot2_f32_bf16 v18, v122, v4, v18
  v_add_f32 v20, v20, v21
  v_dot2_f32_bf16 v18, v123, v5, v18
  s_waitcnt lgkmcnt(0)
  v_cmp_le_i32 vcc, 32, v0
  v_dot2_f32_bf16 v19, v124, v2, 0
  v_add_f32_dpp v22, v20, v20 row_ror:8 row_mask:0xf bank_mask:0xc
  v_dot2_f32_bf16 v19, v125, v3, v19
  v_dot2_f32_bf16 v19, v126, v4, v19
  v_add_f32_dpp v23, v22, v22 row_half_mirror row_mask:0xf bank_mask:0xf
  v_dot2_f32_bf16 v19, v127, v5, v19
  s_cbranch_vccnz L_em7
  s_waitcnt vmcnt(3)
L_em7:
  s_waitcnt vmcnt(5)
  buffer_load_dwordx4 v[192:195], v1, s[40:43], s56 offen nt
  s_add_u32 s56, s56, 4096
  v_dot2_f32_bf16 v20, v168, v2, 0
  v_permlane16_swap_b32 v18, v19
  v_dot2_f32_bf16 v20, v169, v3, v20
  v_dot2_f32_bf16 v20, v170, v4, v20
  v_add_f32 v18, v18, v19
  v_dot2_f32_bf16 v20, v171, v5, v20
  ds_read_b32 v0, v35 offset:4688
  s_cbranch_vccnz L_em8
  s_waitcnt vmcnt(3)
L_em8:
  s_waitcnt vmcnt(5)
  buffer_load_dwordx4 v[196:199], v1, s[40:43], s56 offen nt
  s_add_u32 s56, s56, 4096
  v_dot2_f32_bf16 v21, v172, v2, 0
  v_add_f32_dpp v22, v18, v18 row_ror:8 row_mask:0xf bank_mask:0xf
  v_dot2_f32_bf16 v21, v173, v3, v21
  v_dot2_f32_bf16 v21, v174, v4, v21
  v_dot2_f32_bf16 v21, v175, v5, v21
  s_cbranch_vccnz L_em9
  s_waitcnt vmcnt(3)
L_em9:
  s_waitcnt vmcnt(5)
  buffer_load_dwordx4 v[200:203], v1, s[40:43], s56 offen nt
  s_add_u32 s56, s56, 4096
  v_dot2_f32_bf16 v18, v176, v2, 0
  v_permlane16_swap_b32 v20, v21
  v_dot2_f32_bf16 v18, v177, v3, v18
  v_dot2_f32_bf16 v18, v178, v4, v18
  v_add_f32 v20, v20, v21
  v_dot2_f32_bf16 v18, v179, v5, v18
  s_waitcnt lgkmcnt(0)
  v_cmp_le_i32 vcc, 48, v0
  s_cbranch_vccnz L_em10
  s_waitcnt vmcnt(3)
L_em10:
  s_waitcnt vmcnt(5)
  buffer_load_dwordx4 v[204:207], v1, s[40:43], s56 offen nt
  s_add_u32 s56, s56, 4096
  v_dot2_f32_bf16 v19, v180, v2, 0
  v_add_f32_dpp v22, v20, v20 row_ror:8 row_mask:0xf bank_mask:0xc
  v_dot2_f32_bf16 v19, v181, v3, v19
  v_dot2_f32_bf16 v19, v182, v4, v19
  v_add_f32_dpp v23, v22, v22 row_half_mirror row_mask:0xf bank_mask:0xa
  v_dot2_f32_bf16 v19, v183, v5, v19
  s_cbranch_vccnz L_em11
  s_waitcnt vmcnt(3)
L_em11:
  s_waitcnt vmcnt(5)
  buffer_load_dwordx4 v[40:43], v1, s[40:43], s56 offen nt
  s_add_u32 s56, s56, 4096
  v_dot2_f32_bf16 v20, v184, v2, 0
  v_add_f32_dpp v24, v23, v23 quad_perm:[2,3,0,1] row_mask:0xf bank_mask:0xf
  v_dot2_f32_bf16 v20, v185, v3, v20
  v_dot2_f32_bf16 v20, v186, v4, v20
  v_permlane16_swap_b32 v18, v19
  v_dot2_f32_bf16 v20, v187, v5, v20
  ds_read_b32 v0, v35 offset:4688
  s_cbranch_vccnz L_em12
  s_waitcnt vmcnt(3)
L_em12:
  s_waitcnt vmcnt(5)
  buffer_load_dwordx4 v[44:47], v1, s[40:43], s56 offen nt
  s_add_u32 s56, s56, 4096
  v_dot2_f32_bf16 v21, v188, v2, 0
  v_add_f32 v18, v18, v19
  v_dot2_f32_bf16 v21, v189, v3, v21
  v_dot2_f32_bf16 v21, v190, v4, v21
  v_add_f32_dpp v22, v18, v18 row_ror:8 row_mask:0xf bank_mask:0xf
  v_dot2_f32_bf16 v21, v191, v5, v21
  s_cbranch_vccnz L_em13
  s_waitcnt vmcnt(3)
L_em13:
  s_waitcnt vmcnt(5)
  buffer_load_dwordx4 v[48:51], v1, s[40:43], s56 offen nt
  s_add_u32 s56, s56, 4096
  v_dot2_f32_bf16 v18, v192, v2, 0
  v_permlane16_swap_b32 v20, v21
  v_dot2_f32_bf16 v18, v193, v3, v18
  v_dot2_f32_bf16 v18, v194, v4, v18
  v_add_f32 v20, v20, v21
  v_dot2_f32_bf16 v18, v195, v5, v18
  s_waitcnt lgkmcnt(0)
  v_cmp_le_i32 vcc, 40, v0
  s_cbranch_vccnz L_em14
  s_waitcnt vmcnt(3)
L_em14:
  s_waitcnt vmcnt(5)
  buffer_load_dwordx4 v[52:55], v1, s[40:43], s56 offen nt
  s_add_u32 s56, s56, 4096
  v_dot2_f32_bf16 v19, v196, v2, 0
  v_add_f32_dpp v22, v20, v20 row_ror:8 row_mask:0xf bank_mask:0xc
  v_dot2_f32_bf16 v19, v197, v3, v19
  v_dot2_f32_bf16 v19, v198, v4, v19
  v_add_f32_dpp v23, v22, v22 row_half_mirror row_mask:0xf bank_mask:0xf
  v_dot2_f32_bf16 v19, v199, v5, v19
  ds_read_b32 v0, v35 offset:4688
  s_cbranch_vccnz L_em15
  s_waitcnt vmcnt(3)
L_em15:
  s_waitcnt vmcnt(5)
  buffer_load_dwordx4 v[56:59], v1, s[40:43], s56 offen nt
  s_add_u32 s56, s56, 4096
  v_dot2_f32_bf16 v20, v200, v2, 0
  v_permlane16_swap_b32 v18, v19
  v_dot2_f32_bf16 v20, v201, v3, v20
  v_dot2_f32_bf16 v20, v202, v4, v20
  v_add_f32 v18, v18, v19
  v_dot2_f32_bf16 v20, v203, v5, v20
  s_cbranch_vccnz L_em16
  s_waitcnt vmcnt(3)
L_em16:
  s_waitcnt vmcnt(5)
  buffer_load_dwordx4 v[60:63], v1, s[40:43], s56 offen nt
  s_add_u32 s56, s56, 4096
  v_dot2_f32_bf16 v21, v204, v2, 0
  v_add_f32_dpp v22, v18, v18 row_ror:8 row_mask:0xf bank_mask:0xf
  v_dot2_f32_bf16 v21, v205, v3, v21
  v_dot2_f32_bf16 v21, v206, v4, v21
  v_dot2_f32_bf16 v21, v207, v5, v21
  s_waitcnt lgkmcnt(0)
  v_cmp_le_i32 vcc, 56, v0
  s_nop 0
  v_permlane16_swap_b32 v20, v21
  v_add_f32 v20, v20, v21
  s_nop 1
  v_add_f32_dpp v22, v20, v20 row_ror:8 row_mask:0xf bank_mask:0xc
  s_nop 1
  v_add_f32_dpp v23, v22, v22 row_half_mirror row_mask:0xf bank_mask:0xa
  s_nop 1
  v_add_f32_dpp v25, v23, v23 quad_perm:[2,3,0,1] row_mask:0xf bank_mask:0xf
  v_cndmask_b32 v24, v24, v25, s[60:61]
  s_nop 1
  v_add_f32_dpp v27, v24, v24 quad_perm:[1,0,3,2] row_mask:0xf bank_mask:0xf
  v_cndmask_b32 v26, v26, v27, s[62:63]
  v_cvt_pk_bf16_f32 v26, v26, v26
  v_lshlrev_b32 v17, 16, v26
  v_max_f32 v34, v34, v17
  s_cbranch_vccnz L_em17
  s_waitcnt vmcnt(3)
L_em17:
  s_waitcnt vmcnt(5)
  buffer_load_dwordx4 v[64:67], v1, s[40:43], s56 offen nt
  s_add_u32 s56, s56, 4096
  ds_add_u32 v35, v1 offset:4672
  s_mov_b32 s59, 0
L_kloop:
  v_mov_b32 v10, v11
  v_mov_b32 v11, v12
  v_mov_b32 v12, v13
  v_mov_b32 v13, v14
  v_mov_b32 v14, v15
  v_mov_b32 v15, v16
  v_mov_b32 v16, v17
  v_dot2_f32_bf16 v18, v40, v2, 0
  v_dot2_f32_bf16 v18, v41, v3, v18
  v_dot2_f32_bf16 v18, v42, v4, v18
  v_dot2_f32_bf16 v18, v43, v5, v18
  s_cbranch_vccnz L_em18
  s_waitcnt vmcnt(3)
L_em18:
  s_waitcnt vmcnt(5)
  buffer_load_dwordx4 v[68:71], v1, s[40:43], s56 offen nt
  s_add_u32 s56, s56, 4096
  v_dot2_f32_bf16 v19, v44, v2, 0
  v_dot2_f32_bf16 v19, v45, v3, v19
  v_dot2_f32_bf16 v19, v46, v4, v19
  v_dot2_f32_bf16 v19, v47, v5, v19
  s_cbranch_vccnz L_em19
  s_waitcnt vmcnt(3)
L_em19:
  s_waitcnt vmcnt(5)
  buffer_load_dwordx4 v[72:75], v1, s[40:43], s56 offen nt
  s_add_u32 s56, s56, 4096
  v_dot2_f32_bf16 v20, v48, v2, 0
  v_permlane16_swap_b32 v18, v19
  v_dot2_f32_bf16 v20, v49, v3, v20
  v_dot2_f32_bf16 v20, v50, v4, v20
  v_add_f32 v18, v18, v19
  v_dot2_f32_bf16 v20, v51, v5, v20
  ds_read_b32 v0, v35 offset:4688
  s_cbranch_vccnz L_em20
  s_waitcnt vmcnt(3)
L_em20:
  s_waitcnt vmcnt(5)
  buffer_load_dwordx4 v[76:79], v1, s[40:43], s56 offen nt
  s_add_u32 s56, s56, 4096
  v_dot2_f32_bf16 v21, v52, v2, 0
  v_add_f32_dpp v22, v18, v18 row_ror:8 row_mask:0xf bank_mask:0xf
  v_dot2_f32_bf16 v21, v53, v3, v21
  v_dot2_f32_bf16 v21, v54, v4, v21
  v_dot2_f32_bf16 v21, v55, v5, v21
  s_cbranch_vccnz L_em21
  s_waitcnt vmcnt(3)
L_em21:
  s_waitcnt vmcnt(5)
  buffer_load_dwordx4 v[80:83], v1, s[40:43], s56 offen nt
  s_add_u32 s56, s56, 4096
  v_dot2_f32_bf16 v18, v56, v2, 0
  v_permlane16_swap_b32 v20, v21
  v_dot2_f32_bf16 v18, v57, v3, v18
  v_dot2_f32_bf16 v18, v58, v4, v18
  v_add_f32 v20, v20, v21
  v_dot2_f32_bf16 v18, v59, v5, v18
  s_waitcnt lgkmcnt(0)
  v_cmp_le_i32 vcc, 32, v0
  s_cbranch_vccnz L_em22
  s_waitcnt vmcnt(3)
L_em22:
  s_waitcnt vmcnt(5)
  buffer_load_dwordx4 v[84:87], v1, s[40:43], s56 offen nt
  s_add_u32 s56, s56, 4096
  v_dot2_f32_bf16 v19, v60, v2, 0
  v_add_f32_dpp v22, v20, v20 row_ror:8 row_mask:0xf bank_mask:0xc
  v_dot2_f32_bf16 v19, v61, v3, v19
  v_dot2_f32_bf16 v19, v62, v4, v19
  v_add_f32_dpp v23, v22, v22 row_half_mirror row_mask:0xf bank_mask:0xf
  v_dot2_f32_bf16 v19, v63, v5, v19
  s_cbranch_vccnz L_em23
  s_waitcnt vmcnt(3)
L_em23:
  s_waitcnt vmcnt(5)
  buffer_load_dwordx4 v[88:91], v1, s[40:43], s56 offen nt
  s_add_u32 s56, s56, 4096
  v_dot2_f32_bf16 v20, v64, v2, 0
  v_permlane16_swap_b32 v18, v19
  v_dot2_f32_bf16 v20, v65, v3, v20
  v_dot2_f32_bf16 v20, v66, v4, v20
  v_add_f32 v18, v18, v19
  v_dot2_f32_bf16 v20, v67, v5, v20
  ds_read_b32 v0, v35 offset:4688
  s_cbranch_vccnz L_em24
  s_waitcnt vmcnt(3)
L_em24:
  s_waitcnt vmcnt(5)
  buffer_load_dwordx4 v[92:95], v1, s[40:43], s56 offen nt
  s_add_u32 s56, s56, 4096
  v_dot2_f32_bf16 v21, v68, v2, 0
  v_add_f32_dpp v22, v18, v18 row_ror:8 row_mask:0xf bank_mask:0xf
  v_dot2_f32_bf16 v21, v69, v3, v21
  v_dot2_f32_bf16 v21, v70, v4, v21
  v_dot2_f32_bf16 v21, v71, v5, v21
  s_cbranch_vccnz L_em25
  s_waitcnt vmcnt(3)
L_em25:
  s_waitcnt vmcnt(5)
  buffer_load_dwordx4 v[96:99], v1, s[40:43], s56 offen nt
  s_add_u32 s56, s56, 4096
  v_dot2_f32_bf16 v18, v72, v2, 0
  v_permlane16_swap_b32 v20, v21
  v_dot2_f32_bf16 v18, v73, v3, v18
  v_dot2_f32_bf16 v18, v74, v4, v18
  v_add_f32 v20, v20, v21
  v_dot2_f32_bf16 v18, v75, v5, v18
  s_waitcnt lgkmcnt(0)
  v_cmp_le_i32 vcc, 48, v0
  s_cbranch_vccnz L_em26
  s_waitcnt vmcnt(3)
L_em26:
  s_waitcnt vmcnt(5)
  buffer_load_dwordx4 v[100:103], v1, s[40:43], s56 offen nt
  s_add_u32 s56, s56, 4096
  v_dot2_f32_bf16 v19, v76, v2, 0
  v_add_f32_dpp v22, v20, v20 row_ror:8 row_mask:0xf bank_mask:0xc
  v_dot2_f32_bf16 v19, v77, v3, v19
  v_dot2_f32_bf16 v19, v78, v4, v19
  v_add_f32_dpp v23, v22, v22 row_half_mirror row_mask:0xf bank_mask:0xa
  v_dot2_f32_bf16 v19, v79, v5, v19
  s_cbranch_vccnz L_em27
  s_waitcnt vmcnt(3)
L_em27:
  s_waitcnt vmcnt(5)
  buffer_load_dwordx4 v[104:107], v1, s[40:43], s56 offen nt
  s_add_u32 s56, s56, 4096
  v_dot2_f32_bf16 v20, v80, v2, 0
  v_add_f32_dpp v24, v23, v23 quad_perm:[2,3,0,1] row_mask:0xf bank_mask:0xf
  v_dot2_f32_bf16 v20, v81, v3, v20
  v_dot2_f32_bf16 v20, v82, v4, v20
  v_permlane16_swap_b32 v18, v19
  v_dot2_f32_bf16 v20, v83, v5, v20
  ds_read_b32 v0, v35 offset:4688
  s_cbranch_vccnz L_em28
  s_waitcnt vmcnt(3)
L_em28:
  s_waitcnt vmcnt(5)
  buffer_load_dwordx4 v[108:111], v1, s[40:43], s56 offen nt
  s_add_u32 s56, s56, 4096
  v_dot2_f32_bf16 v21, v84, v2, 0
  v_add_f32 v18, v18, v19
  v_dot2_f32_bf16 v21, v85, v3, v21
  v_dot2_f32_bf16 v21, v86, v4, v21
  v_add_f32_dpp v22, v18, v18 row_ror:8 row_mask:0xf bank_mask:0xf
  v_dot2_f32_bf16 v21, v87, v5, v21
  s_cbranch_vccnz L_em29
  s_waitcnt vmcnt(3)
L_em29:
  s_waitcnt vmcnt(5)
  buffer_load_dwordx4 v[112:115], v1, s[40:43], s56 offen nt
  s_add_u32 s56, s56, 4096
  v_dot2_f32_bf16 v18, v88, v2, 0
  v_permlane16_swap_b32 v20, v21
  v_dot2_f32_bf16 v18, v89, v3, v18
  v_dot2_f32_bf16 v18, v90, v4, v18
  v_add_f32 v20, v20, v21
  v_dot2_f32_bf16 v18, v91, v5, v18
  s_waitcnt lgkmcnt(0)
  v_cmp_le_i32 vcc, 40, v0
  s_cbranch_vccnz L_em30
  s_waitcnt vmcnt(3)
L_em30:
  s_waitcnt vmcnt(5)
  buffer_load_dwordx4 v[116:119], v1, s[40:43], s56 offen nt
  s_add_u32 s56, s56, 4096
  v_dot2_f32_bf16 v19, v92, v2, 0
  v_add_f32_dpp v22, v20, v20 row_ror:8 row_mask:0xf bank_mask:0xc
  v_dot2_f32_bf16 v19, v93, v3, v19
  v_dot2_f32_bf16 v19, v94, v4, v19
  v_add_f32_dpp v23, v22, v22 row_half_mirror row_mask:0xf bank_mask:0xf
  v_dot2_f32_bf16 v19, v95, v5, v19
  s_cbranch_vccnz L_em31
  s_waitcnt vmcnt(3)
L_em31:
  s_waitcnt vmcnt(5)
  buffer_load_dwordx4 v[120:123], v1, s[40:43], s56 offen nt
  s_add_u32 s56, s56, 4096
  v_dot2_f32_bf16 v20, v96, v2, 0
  v_permlane16_swap_b32 v18, v19
  v_dot2_f32_bf16 v20, v97, v3, v20
  v_dot2_f32_bf16 v20, v98, v4, v20
  v_add_f32 v18, v18, v19
  v_dot2_f32_bf16 v20, v99, v5, v20
  ds_read_b32 v0, v35 offset:4688
  s_cbranch_vccnz L_em32
  s_waitcnt vmcnt(3)
L_em32:
  s_waitcnt vmcnt(5)
  buffer_load_dwordx4 v[124:127], v1, s[40:43], s56 offen nt
  s_add_u32 s56, s56, 4096
  v_dot2_f32_bf16 v21, v100, v2, 0
  v_add_f32_dpp v22, v18, v18 row_ror:8 row_mask:0xf bank_mask:0xf
  v_dot2_f32_bf16 v21, v101, v3, v21
  v_dot2_f32_bf16 v21, v102, v4, v21
  v_dot2_f32_bf16 v21, v103, v5, v21
  ds_add_u32 v35, v1 offset:4672
  s_cbranch_vccnz L_em33
  s_waitcnt vmcnt(3)
L_em33:
  s_waitcnt vmcnt(5)
  buffer_load_dwordx4 v[128:131], v1, s[40:43], s56 offen nt
  s_add_u32 s56, s56, 4096
  v_dot2_f32_bf16 v18, v104, v2, 0
  v_permlane16_swap_b32 v20, v21
  v_dot2_f32_bf16 v18, v105, v3, v18
  v_dot2_f32_bf16 v18, v106, v4, v18
  v_add_f32 v20, v20, v21
  v_dot2_f32_bf16 v18, v107, v5, v18
  s_waitcnt lgkmcnt(0)
  v_cmp_le_i32 vcc, 56, v0
  s_cbranch_vccnz L_em34
  s_waitcnt vmcnt(3)
L_em34:
  s_waitcnt vmcnt(5)
  buffer_load_dwordx4 v[132:135], v1, s[40:43], s56 offen nt
  s_add_u32 s56, s56, 4096
  v_dot2_f32_bf16 v19, v108, v2, 0
  v_add_f32_dpp v22, v20, v20 row_ror:8 row_mask:0xf bank_mask:0xc
  v_dot2_f32_bf16 v19, v109, v3, v19
  v_dot2_f32_bf16 v19, v110, v4, v19
  v_add_f32_dpp v23, v22, v22 row_half_mirror row_mask:0xf bank_mask:0xa
  v_dot2_f32_bf16 v19, v111, v5, v19
  s_cbranch_vccnz L_em35
  s_waitcnt vmcnt(3)
L_em35:
  s_waitcnt vmcnt(5)
  buffer_load_dwordx4 v[136:139], v1, s[40:43], s56 offen nt
  s_add_u32 s56, s56, 4096
  v_dot2_f32_bf16 v20, v112, v2, 0
  v_add_f32_dpp v25, v23, v23 quad_perm:[2,3,0,1] row_mask:0xf bank_mask:0xf
  v_dot2_f32_bf16 v20, v113, v3, v20
  v_dot2_f32_bf16 v20, v114, v4, v20
  v_cndmask_b32 v24, v24, v25, s[60:61]
  v_dot2_f32_bf16 v20, v115, v5, v20
  ds_read_b32 v0, v35 offset:4688
  s_cbranch_vccnz L_em36
  s_waitcnt vmcnt(3)
L_em36:
  s_waitcnt vmcnt(5)
  buffer_load_dwordx4 v[140:143], v1, s[40:43], s56 offen nt
  s_add_u32 s56, s56, 4096
  v_dot2_f32_bf16 v21, v116, v2, 0
  v_add_f32_dpp v26, v24, v24 quad_perm:[1,0,3,2] row_mask:0xf bank_mask:0xf
  v_dot2_f32_bf16 v21, v117, v3, v21
  v_dot2_f32_bf16 v21, v118, v4, v21
  v_permlane16_swap_b32 v18, v19
  v_dot2_f32_bf16 v21, v119, v5, v21
  s_cbranch_vccnz L_em37
  s_waitcnt vmcnt(3)
L_em37:
  s_waitcnt vmcnt(5)
  buffer_load_dwordx4 v[144:147], v1, s[40:43], s56 offen nt
  s_add_u32 s56, s56, 4096
  v_add_f32 v18, v18, v19
  s_nop 1
  v_add_f32_dpp v22, v18, v18 row_ror:8 row_mask:0xf bank_mask:0xf
  v_dot2_f32_bf16 v18, v120, v2, 0
  v_permlane16_swap_b32 v20, v21
  v_dot2_f32_bf16 v18, v121, v3, v18
  v_dot2_f32_bf16 v18, v122, v4, v18
  v_add_f32 v20, v20, v21
  v_dot2_f32_bf16 v18, v123, v5, v18
  s_waitcnt lgkmcnt(0)
  v_cmp_le_i32 vcc, 32, v0
  s_cbranch_vccnz L_em38
  s_waitcnt vmcnt(3)
L_em38:
  s_waitcnt vmcnt(5)
  buffer_load_dwordx4 v[148:151], v1, s[40:43], s56 offen nt
  s_add_u32 s56, s56, 4096
  v_dot2_f32_bf16 v19, v124, v2, 0
  v_add_f32_dpp v22, v20, v20 row_ror:8 row_mask:0xf bank_mask:0xc
  v_dot2_f32_bf16 v19, v125, v3, v19
  v_dot2_f32_bf16 v19, v126, v4, v19
  v_add_f32_dpp v23, v22, v22 row_half_mirror row_mask:0xf bank_mask:0xf
  v_dot2_f32_bf16 v19, v127, v5, v19
  s_cbranch_vccnz L_em39
  s_waitcnt vmcnt(3)
L_em39:
  s_waitcnt vmcnt(5)
  buffer_load_dwordx4 v[152:155], v1, s[40:43], s56 offen nt
  s_add_u32 s56, s56, 4096
  v_dot2_f32_bf16 v20, v128, v2, 0
  v_permlane16_swap_b32 v18, v19
  v_dot2_f32_bf16 v20, v129, v3, v20
  v_dot2_f32_bf16 v20, v130, v4, v20
  v_add_f32 v18, v18, v19
  v_dot2_f32_bf16 v20, v131, v5, v20
  ds_read_b32 v0, v35 offset:4688
  s_cbranch_vccnz L_em40
  s_waitcnt vmcnt(3)
L_em40:
  s_waitcnt vmcnt(5)
  buffer_load_dwordx4 v[156:159], v1, s[40:43], s56 offen nt
  s_add_u32 s56, s56, 4096
  v_dot2_f32_bf16 v21, v132, v2, 0
  v_add_f32_dpp v22, v18, v18 row_ror:8 row_mask:0xf bank_mask:0xf
  v_dot2_f32_bf16 v21, v133, v3, v21
  v_dot2_f32_bf16 v21, v134, v4, v21
  v_dot2_f32_bf16 v21, v135, v5, v21
  s_cbranch_vccnz L_em41
  s_waitcnt vmcnt(3)
L_em41:
  s_waitcnt vmcnt(5)
  buffer_load_dwordx4 v[160:163], v1, s[40:43], s56 offen nt
  s_add_u32 s56, s56, 4096
  v_dot2_f32_bf16 v18, v136, v2, 0
  v_permlane16_swap_b32 v20, v21
  v_dot2_f32_bf16 v18, v137, v3, v18
  v_dot2_f32_bf16 v18, v138, v4, v18
  v_add_f32 v20, v20, v21
  v_dot2_f32_bf16 v18, v139, v5, v18
  s_waitcnt lgkmcnt(0)
  v_cmp_le_i32 vcc, 48, v0
  s_cbranch_vccnz L_em42
  s_waitcnt vmcnt(3)
L_em42:
  s_waitcnt vmcnt(5)
  buffer_load_dwordx4 v[164:167], v1, s[40:43], s56 offen nt
  s_add_u32 s56, s56, 4096
  v_dot2_f32_bf16 v19, v140, v2, 0
  v_add_f32_dpp v22, v20, v20 row_ror:8 row_mask:0xf bank_mask:0xc
  v_dot2_f32_bf16 v19, v141, v3, v19
  v_dot2_f32_bf16 v19, v142, v4, v19
  v_add_f32_dpp v23, v22, v22 row_half_mirror row_mask:0xf bank_mask:0xa
  v_dot2_f32_bf16 v19, v143, v5, v19
  s_cbranch_vccnz L_em43
  s_waitcnt vmcnt(3)
L_em43:
  s_waitcnt vmcnt(5)
  buffer_load_dwordx4 v[40:43], v1, s[40:43], s56 offen nt
  s_add_u32 s56, s56, 4096
  v_dot2_f32_bf16 v20, v144, v2, 0
  v_add_f32_dpp v24, v23, v23 quad_perm:[2,3,0,1] row_mask:0xf bank_mask:0xf
  v_dot2_f32_bf16 v20, v145, v3, v20
  v_dot2_f32_bf16 v20, v146, v4, v20
  v_permlane16_swap_b32 v18, v19
  v_dot2_f32_bf16 v20, v147, v5, v20
  ds_read_b32 v0, v35 offset:4688
  s_cbranch_vccnz L_em44
  s_waitcnt vmcnt(3)
L_em44:
  s_waitcnt vmcnt(5)
  buffer_load_dwordx4 v[44:47], v1, s[40:43], s56 offen nt
  s_add_u32 s56, s56, 4096
  v_dot2_f32_bf16 v21, v148, v2, 0
  v_add_f32 v18, v18, v19
  v_dot2_f32_bf16 v21, v149, v3, v21
  v_dot2_f32_bf16 v21, v150, v4, v21
  v_add_f32_dpp v22, v18, v18 row_ror:8 row_mask:0xf bank_mask:0xf
  v_dot2_f32_bf16 v21, v151, v5, v21
  s_cbranch_vccnz L_em45
  s_waitcnt vmcnt(3)
L_em45:
  s_waitcnt vmcnt(5)
  buffer_load_dwordx4 v[48:51], v1, s[40:43], s56 offen nt
  s_add_u32 s56, s56, 4096
  v_dot2_f32_bf16 v18, v152, v2, 0
  v_permlane16_swap_b32 v20, v21
  v_dot2_f32_bf16 v18, v153, v3, v18
  v_dot2_f32_bf16 v18, v154, v4, v18
  v_add_f32 v20, v20, v21
  v_dot2_f32_bf16 v18, v155, v5, v18
  s_waitcnt lgkmcnt(0)
  v_cmp_le_i32 vcc, 40, v0
  s_cbranch_vccnz L_em46
  s_waitcnt vmcnt(3)
L_em46:
  s_waitcnt vmcnt(5)
  buffer_load_dwordx4 v[52:55], v1, s[40:43], s56 offen nt
  s_add_u32 s56, s56, 4096
  v_dot2_f32_bf16 v19, v156, v2, 0
  v_add_f32_dpp v22, v20, v20 row_ror:8 row_mask:0xf bank_mask:0xc
  v_dot2_f32_bf16 v19, v157, v3, v19
  v_dot2_f32_bf16 v19, v158, v4, v19
  v_add_f32_dpp v23, v22, v22 row_half_mirror row_mask:0xf bank_mask:0xf
  v_dot2_f32_bf16 v19, v159, v5, v19
  ds_read_b32 v0, v35 offset:4688
  s_cbranch_vccnz L_em47
  s_waitcnt vmcnt(3)
L_em47:
  s_waitcnt vmcnt(5)
  buffer_load_dwordx4 v[56:59], v1, s[40:43], s56 offen nt
  s_add_u32 s56, s56, 4096
  v_dot2_f32_bf16 v20, v160, v2, 0
  v_permlane16_swap_b32 v18, v19
  v_dot2_f32_bf16 v20, v161, v3, v20
  v_dot2_f32_bf16 v20, v162, v4, v20
  v_add_f32 v18, v18, v19
  v_dot2_f32_bf16 v20, v163, v5, v20
  s_cbranch_vccnz L_em48
  s_waitcnt vmcnt(3)
L_em48:
  s_waitcnt vmcnt(5)
  buffer_load_dwordx4 v[60:63], v1, s[40:43], s56 offen nt
  s_add_u32 s56, s56, 4096
  v_dot2_f32_bf16 v21, v164, v2, 0
  v_add_f32_dpp v22, v18, v18 row_ror:8 row_mask:0xf bank_mask:0xf
  v_dot2_f32_bf16 v21, v165, v3, v21
  v_dot2_f32_bf16 v21, v166, v4, v21
  v_dot2_f32_bf16 v21, v167, v5, v21
  s_waitcnt lgkmcnt(0)
  v_cmp_le_i32 vcc, 56, v0
  s_nop 0
  v_permlane16_swap_b32 v20, v21
  v_add_f32 v20, v20, v21
  s_nop 1
  v_add_f32_dpp v22, v20, v20 row_ror:8 row_mask:0xf bank_mask:0xc
  s_nop 1
  v_add_f32_dpp v23, v22, v22 row_half_mirror row_mask:0xf bank_mask:0xa
  s_nop 1
  v_add_f32_dpp v25, v23, v23 quad_perm:[2,3,0,1] row_mask:0xf bank_mask:0xf
  v_cndmask_b32 v24, v24, v25, s[60:61]
  s_nop 1
  v_add_f32_dpp v27, v24, v24 quad_perm:[1,0,3,2] row_mask:0xf bank_mask:0xf
  v_cndmask_b32 v26, v26, v27, s[62:63]
  v_cvt_pk_bf16_f32 v26, v26, v26
  v_lshlrev_b32 v17, 16, v26
  v_max_f32 v34, v34, v17
  s_cbranch_vccnz L_em49
  s_waitcnt vmcnt(3)
L_em49:
  s_waitcnt vmcnt(5)
  buffer_load_dwordx4 v[64:67], v1, s[40:43], s56 offen nt
  s_add_u32 s56, s56, 4096
  ds_add_u32 v35, v1 offset:4672
  s_add_u32 s59, s59, 1
  s_cmp_lt_u32 s59, 5
  s_cbranch_scc1 L_kloop
  v_mov_b32 v10, v11
  v_mov_b32 v11, v12
  v_mov_b32 v12, v13
  v_mov_b32 v13, v14
  v_mov_b32 v14, v15
  v_mov_b32 v15, v16
  v_mov_b32 v16, v17
  v_dot2_f32_bf16 v18, v40, v2, 0
  v_dot2_f32_bf16 v18, v41, v3, v18
  v_dot2_f32_bf16 v18, v42, v4, v18
  v_dot2_f32_bf16 v18, v43, v5, v18
  s_cbranch_vccnz L_em50
  s_waitcnt vmcnt(3)
L_em50:
  s_waitcnt vmcnt(5)
  buffer_load_dwordx4 v[68:71], v1, s[40:43], s56 offen nt
  s_add_u32 s56, s56, 4096
  v_dot2_f32_bf16 v19, v44, v2, 0
  v_dot2_f32_bf16 v19, v45, v3, v19
  v_dot2_f32_bf16 v19, v46, v4, v19
  v_dot2_f32_bf16 v19, v47, v5, v19
  s_cbranch_vccnz L_em51
  s_waitcnt vmcnt(3)
L_em51:
  s_waitcnt vmcnt(5)
  buffer_load_dwordx4 v[72:75], v1, s[40:43], s56 offen nt
  s_add_u32 s56, s56, 4096
  v_dot2_f32_bf16 v20, v48, v2, 0
  v_permlane16_swap_b32 v18, v19
  v_dot2_f32_bf16 v20, v49, v3, v20
  v_dot2_f32_bf16 v20, v50, v4, v20
  v_add_f32 v18, v18, v19
  v_dot2_f32_bf16 v20, v51, v5, v20
  ds_read_b32 v0, v35 offset:4688
  s_cbranch_vccnz L_em52
  s_waitcnt vmcnt(3)
L_em52:
  s_waitcnt vmcnt(5)
  buffer_load_dwordx4 v[76:79], v1, s[40:43], s56 offen nt
  s_add_u32 s56, s56, 4096
  v_dot2_f32_bf16 v21, v52, v2, 0
  v_add_f32_dpp v22, v18, v18 row_ror:8 row_mask:0xf bank_mask:0xf
  v_dot2_f32_bf16 v21, v53, v3, v21
  v_dot2_f32_bf16 v21, v54, v4, v21
  v_dot2_f32_bf16 v21, v55, v5, v21
  s_cbranch_vccnz L_em53
  s_waitcnt vmcnt(3)
L_em53:
  s_waitcnt vmcnt(5)
  buffer_load_dwordx4 v[80:83], v1, s[40:43], s56 offen nt
  s_add_u32 s56, s56, 4096
  v_dot2_f32_bf16 v18, v56, v2, 0
  v_permlane16_swap_b32 v20, v21
  v_dot2_f32_bf16 v18, v57, v3, v18
  v_dot2_f32_bf16 v18, v58, v4, v18
  v_add_f32 v20, v20, v21
  v_dot2_f32_bf16 v18, v59, v5, v18
  s_waitcnt lgkmcnt(0)
  v_cmp_le_i32 vcc, 32, v0
  s_cbranch_vccnz L_em54
  s_waitcnt vmcnt(3)
L_em54:
  s_waitcnt vmcnt(5)
  buffer_load_dwordx4 v[84:87], v1, s[40:43], s56 offen nt
  s_add_u32 s56, s56, 4096
  v_dot2_f32_bf16 v19, v60, v2, 0
  v_add_f32_dpp v22, v20, v20 row_ror:8 row_mask:0xf bank_mask:0xc
  v_dot2_f32_bf16 v19, v61, v3, v19
  v_dot2_f32_bf16 v19, v62, v4, v19
  v_add_f32_dpp v23, v22, v22 row_half_mirror row_mask:0xf bank_mask:0xf
  v_dot2_f32_bf16 v19, v63, v5, v19
  s_cbranch_vccnz L_em55
  s_waitcnt vmcnt(3)
L_em55:
  s_waitcnt vmcnt(5)
  buffer_load_dwordx4 v[88:91], v1, s[40:43], s56 offen nt
  s_add_u32 s56, s56, 4096
  v_dot2_f32_bf16 v20, v64, v2, 0
  v_permlane16_swap_b32 v18, v19
  v_dot2_f32_bf16 v20, v65, v3, v20
  v_dot2_f32_bf16 v20, v66, v4, v20
  v_add_f32 v18, v18, v19
  v_dot2_f32_bf16 v20, v67, v5, v20
  ds_read_b32 v0, v35 offset:4688
  s_cbranch_vccnz L_em56
  s_waitcnt vmcnt(3)
L_em56:
  s_waitcnt vmcnt(5)
  buffer_load_dwordx4 v[92:95], v1, s[40:43], s56 offen nt
  s_add_u32 s56, s56, 4096
  v_dot2_f32_bf16 v21, v68, v2, 0
  v_add_f32_dpp v22, v18, v18 row_ror:8 row_mask:0xf bank_mask:0xf
  v_dot2_f32_bf16 v21, v69, v3, v21
  v_dot2_f32_bf16 v21, v70, v4, v21
  v_dot2_f32_bf16 v21, v71, v5, v21
  s_cbranch_vccnz L_em57
  s_waitcnt vmcnt(3)
L_em57:
  s_waitcnt vmcnt(5)
  buffer_load_dwordx4 v[96:99], v1, s[40:43], s56 offen nt
  s_add_u32 s56, s56, 4096
  v_dot2_f32_bf16 v18, v72, v2, 0
  v_permlane16_swap_b32 v20, v21
  v_dot2_f32_bf16 v18, v73, v3, v18
  v_dot2_f32_bf16 v18, v74, v4, v18
  v_add_f32 v20, v20, v21
  v_dot2_f32_bf16 v18, v75, v5, v18
  s_waitcnt lgkmcnt(0)
  v_cmp_le_i32 vcc, 48, v0
  s_cbranch_vccnz L_em58
  s_waitcnt vmcnt(3)
L_em58:
  s_waitcnt vmcnt(5)
  buffer_load_dwordx4 v[100:103], v1, s[40:43], s56 offen nt
  s_add_u32 s56, s56, 4096
  v_dot2_f32_bf16 v19, v76, v2, 0
  v_add_f32_dpp v22, v20, v20 row_ror:8 row_mask:0xf bank_mask:0xc
  v_dot2_f32_bf16 v19, v77, v3, v19
  v_dot2_f32_bf16 v19, v78, v4, v19
  v_add_f32_dpp v23, v22, v22 row_half_mirror row_mask:0xf bank_mask:0xa
  v_dot2_f32_bf16 v19, v79, v5, v19
  s_cbranch_vccnz L_em59
  s_waitcnt vmcnt(3)
L_em59:
  s_waitcnt vmcnt(5)
  buffer_load_dwordx4 v[104:107], v1, s[40:43], s56 offen nt
  s_add_u32 s56, s56, 4096
  v_dot2_f32_bf16 v20, v80, v2, 0
  v_add_f32_dpp v24, v23, v23 quad_perm:[2,3,0,1] row_mask:0xf bank_mask:0xf
  v_dot2_f32_bf16 v20, v81, v3, v20
  v_dot2_f32_bf16 v20, v82, v4, v20
  v_permlane16_swap_b32 v18, v19
  v_dot2_f32_bf16 v20, v83, v5, v20
  ds_read_b32 v0, v35 offset:4688
  s_cbranch_vccnz L_em60
  s_waitcnt vmcnt(3)
L_em60:
  s_waitcnt vmcnt(5)
  buffer_load_dwordx4 v[108:111], v1, s[40:43], s56 offen nt
  s_add_u32 s56, s56, 4096
  v_dot2_f32_bf16 v21, v84, v2, 0
  v_add_f32 v18, v18, v19
  v_dot2_f32_bf16 v21, v85, v3, v21
  v_dot2_f32_bf16 v21, v86, v4, v21
  v_add_f32_dpp v22, v18, v18 row_ror:8 row_mask:0xf bank_mask:0xf
  v_dot2_f32_bf16 v21, v87, v5, v21
  s_cbranch_vccnz L_em61
  s_waitcnt vmcnt(3)
L_em61:
  s_waitcnt vmcnt(5)
  buffer_load_dwordx4 v[112:115], v1, s[40:43], s56 offen nt
  s_add_u32 s56, s56, 4096
  v_dot2_f32_bf16 v18, v88, v2, 0
  v_permlane16_swap_b32 v20, v21
  v_dot2_f32_bf16 v18, v89, v3, v18
  v_dot2_f32_bf16 v18, v90, v4, v18
  v_add_f32 v20, v20, v21
  v_dot2_f32_bf16 v18, v91, v5, v18
  s_waitcnt lgkmcnt(0)
  v_cmp_le_i32 vcc, 40, v0
  s_cbranch_vccnz L_em62
  s_waitcnt vmcnt(3)
L_em62:
  s_waitcnt vmcnt(5)
  buffer_load_dwordx4 v[116:119], v1, s[40:43], s56 offen nt
  s_add_u32 s56, s56, 4096
  v_dot2_f32_bf16 v19, v92, v2, 0
  v_add_f32_dpp v22, v20, v20 row_ror:8 row_mask:0xf bank_mask:0xc
  v_dot2_f32_bf16 v19, v93, v3, v19
  v_dot2_f32_bf16 v19, v94, v4, v19
  v_add_f32_dpp v23, v22, v22 row_half_mirror row_mask:0xf bank_mask:0xf
  v_dot2_f32_bf16 v19, v95, v5, v19
  s_cbranch_vccnz L_em63
  s_waitcnt vmcnt(3)
L_em63:
  s_waitcnt vmcnt(5)
  buffer_load_dwordx4 v[120:123], v1, s[40:43], s56 offen nt
  s_add_u32 s56, s56, 4096
  v_dot2_f32_bf16 v20, v96, v2, 0
  v_permlane16_swap_b32 v18, v19
  v_dot2_f32_bf16 v20, v97, v3, v20
  v_dot2_f32_bf16 v20, v98, v4, v20
  v_add_f32 v18, v18, v19
  v_dot2_f32_bf16 v20, v99, v5, v20
  ds_read_b32 v0, v35 offset:4688
  s_cbranch_vccnz L_em64
  s_waitcnt vmcnt(3)
L_em64:
  s_waitcnt vmcnt(5)
  buffer_load_dwordx4 v[124:127], v1, s[40:43], s56 offen nt
  s_add_u32 s56, s56, 4096
  v_dot2_f32_bf16 v21, v100, v2, 0
  v_add_f32_dpp v22, v18, v18 row_ror:8 row_mask:0xf bank_mask:0xf
  v_dot2_f32_bf16 v21, v101, v3, v21
  v_dot2_f32_bf16 v21, v102, v4, v21
  v_dot2_f32_bf16 v21, v103, v5, v21
  ds_add_u32 v35, v1 offset:4672
  s_cbranch_vccnz L_em65
  s_waitcnt vmcnt(3)
L_em65:
  s_waitcnt vmcnt(5)
  buffer_load_dwordx4 v[128:131], v1, s[40:43], s56 offen nt
  s_add_u32 s56, s56, 4096
  v_dot2_f32_bf16 v18, v104, v2, 0
  v_permlane16_swap_b32 v20, v21
  v_dot2_f32_bf16 v18, v105, v3, v18
  v_dot2_f32_bf16 v18, v106, v4, v18
  v_add_f32 v20, v20, v21
  v_dot2_f32_bf16 v18, v107, v5, v18
  s_waitcnt lgkmcnt(0)
  v_cmp_le_i32 vcc, 56, v0
  s_cbranch_vccnz L_em66
  s_waitcnt vmcnt(3)
L_em66:
  s_waitcnt vmcnt(5)
  buffer_load_dwordx4 v[132:135], v1, s[40:43], s56 offen nt
  s_add_u32 s56, s56, 4096
  v_dot2_f32_bf16 v19, v108, v2, 0
  v_add_f32_dpp v22, v20, v20 row_ror:8 row_mask:0xf bank_mask:0xc
  v_dot2_f32_bf16 v19, v109, v3, v19
  v_dot2_f32_bf16 v19, v110, v4, v19
  v_add_f32_dpp v23, v22, v22 row_half_mirror row_mask:0xf bank_mask:0xa
  v_dot2_f32_bf16 v19, v111, v5, v19
  s_cbranch_vccnz L_em67
  s_waitcnt vmcnt(3)
L_em67:
  s_waitcnt vmcnt(5)
  buffer_load_dwordx4 v[136:139], v1, s[40:43], s56 offen nt
  s_add_u32 s56, s56, 4096
  v_dot2_f32_bf16 v20, v112, v2, 0
  v_add_f32_dpp v25, v23, v23 quad_perm:[2,3,0,1] row_mask:0xf bank_mask:0xf
  v_dot2_f32_bf16 v20, v113, v3, v20
  v_dot2_f32_bf16 v20, v114, v4, v20
  v_cndmask_b32 v24, v24, v25, s[60:61]
  v_dot2_f32_bf16 v20, v115, v5, v20
  ds_read_b32 v0, v35 offset:4688
  s_cbranch_vccnz L_em68
  s_waitcnt vmcnt(3)
L_em68:
  s_waitcnt vmcnt(5)
  buffer_load_dwordx4 v[140:143], v1, s[40:43], s56 offen nt
  s_add_u32 s56, s56, 4096
  v_dot2_f32_bf16 v21, v116, v2, 0
  v_add_f32_dpp v26, v24, v24 quad_perm:[1,0,3,2] row_mask:0xf bank_mask:0xf
  v_dot2_f32_bf16 v21, v117, v3, v21
  v_dot2_f32_bf16 v21, v118, v4, v21
  v_permlane16_swap_b32 v18, v19
  v_dot2_f32_bf16 v21, v119, v5, v21
  s_cbranch_vccnz L_em69
  s_waitcnt vmcnt(3)
L_em69:
  s_waitcnt vmcnt(5)
  buffer_load_dwordx4 v[144:147], v1, s[40:43], s56 offen nt
  s_add_u32 s56, s56, 4096
  v_add_f32 v18, v18, v19
  s_nop 1
  v_add_f32_dpp v22, v18, v18 row_ror:8 row_mask:0xf bank_mask:0xf
  v_dot2_f32_bf16 v18, v120, v2, 0
  v_permlane16_swap_b32 v20, v21
  v_dot2_f32_bf16 v18, v121, v3, v18
  v_dot2_f32_bf16 v18, v122, v4, v18
  v_add_f32 v20, v20, v21
  v_dot2_f32_bf16 v18, v123, v5, v18
  s_waitcnt lgkmcnt(0)
  v_cmp_le_i32 vcc, 32, v0
  s_cbranch_vccnz L_em70
  s_waitcnt vmcnt(3)
L_em70:
  s_waitcnt vmcnt(5)
  buffer_load_dwordx4 v[148:151], v1, s[40:43], s56 offen nt
  s_add_u32 s56, s56, 4096
  v_dot2_f32_bf16 v19, v124, v2, 0
  v_add_f32_dpp v22, v20, v20 row_ror:8 row_mask:0xf bank_mask:0xc
  v_dot2_f32_bf16 v19, v125, v3, v19
  v_dot2_f32_bf16 v19, v126, v4, v19
  v_add_f32_dpp v23, v22, v22 row_half_mirror row_mask:0xf bank_mask:0xf
  v_dot2_f32_bf16 v19, v127, v5, v19
  s_cbranch_vccnz L_em71
  s_waitcnt vmcnt(3)
L_em71:
  s_waitcnt vmcnt(5)
  buffer_load_dwordx4 v[152:155], v1, s[40:43], s56 offen nt
  s_add_u32 s56, s56, 4096
  v_dot2_f32_bf16 v20, v128, v2, 0
  v_permlane16_swap_b32 v18, v19
  v_dot2_f32_bf16 v20, v129, v3, v20
  v_dot2_f32_bf16 v20, v130, v4, v20
  v_add_f32 v18, v18, v19
  v_dot2_f32_bf16 v20, v131, v5, v20
  ds_read_b32 v0, v35 offset:4688
  s_cbranch_vccnz L_em72
  s_waitcnt vmcnt(3)
L_em72:
  s_waitcnt vmcnt(5)
  buffer_load_dwordx4 v[156:159], v1, s[40:43], s56 offen nt
  s_add_u32 s56, s56, 4096
  v_dot2_f32_bf16 v21, v132, v2, 0
  v_add_f32_dpp v22, v18, v18 row_ror:8 row_mask:0xf bank_mask:0xf
  v_dot2_f32_bf16 v21, v133, v3, v21
  v_dot2_f32_bf16 v21, v134, v4, v21
  v_dot2_f32_bf16 v21, v135, v5, v21
  s_cbranch_vccnz L_em73
  s_waitcnt vmcnt(3)
L_em73:
  s_waitcnt vmcnt(5)
  buffer_load_dwordx4 v[160:163], v1, s[40:43], s56 offen nt
  s_add_u32 s56, s56, 4096
  v_dot2_f32_bf16 v18, v136, v2, 0
  v_permlane16_swap_b32 v20, v21
  v_dot2_f32_bf16 v18, v137, v3, v18
  v_dot2_f32_bf16 v18, v138, v4, v18
  v_add_f32 v20, v20, v21
  v_dot2_f32_bf16 v18, v139, v5, v18
  s_waitcnt lgkmcnt(0)
  v_cmp_le_i32 vcc, 48, v0
  s_cbranch_vccnz L_em74
  s_waitcnt vmcnt(3)
L_em74:
  s_waitcnt vmcnt(5)
  buffer_load_dwordx4 v[164:167], v1, s[40:43], s56 offen nt
  s_add_u32 s56, s56, 4096
  v_dot2_f32_bf16 v19, v140, v2, 0
  v_add_f32_dpp v22, v20, v20 row_ror:8 row_mask:0xf bank_mask:0xc
  v_dot2_f32_bf16 v19, v141, v3, v19
  v_dot2_f32_bf16 v19, v142, v4, v19
  v_add_f32_dpp v23, v22, v22 row_half_mirror row_mask:0xf bank_mask:0xa
  v_dot2_f32_bf16 v19, v143, v5, v19
  s_cbranch_vccnz L_em75
  s_waitcnt vmcnt(3)
L_em75:
  s_waitcnt vmcnt(5)
  buffer_load_dwordx4 v[40:43], v1, s[44:47], s58 offen nt
  s_add_u32 s58, s58, 4096
  v_dot2_f32_bf16 v20, v144, v2, 0
  v_add_f32_dpp v24, v23, v23 quad_perm:[2,3,0,1] row_mask:0xf bank_mask:0xf
  v_dot2_f32_bf16 v20, v145, v3, v20
  v_dot2_f32_bf16 v20, v146, v4, v20
  v_permlane16_swap_b32 v18, v19
  v_dot2_f32_bf16 v20, v147, v5, v20
  ds_read_b32 v0, v35 offset:4688
  s_cbranch_vccnz L_em76
  s_waitcnt vmcnt(3)
L_em76:
  s_waitcnt vmcnt(5)
  buffer_load_dwordx4 v[44:47], v1, s[44:47], s58 offen nt
  s_add_u32 s58, s58, 4096
  v_dot2_f32_bf16 v21, v148, v2, 0
  v_add_f32 v18, v18, v19
  v_dot2_f32_bf16 v21, v149, v3, v21
  v_dot2_f32_bf16 v21, v150, v4, v21
  v_add_f32_dpp v22, v18, v18 row_ror:8 row_mask:0xf bank_mask:0xf
  v_dot2_f32_bf16 v21, v151, v5, v21
  s_cbranch_vccnz L_em77
  s_waitcnt vmcnt(3)
L_em77:
  s_waitcnt vmcnt(5)
  buffer_load_dwordx4 v[48:51], v1, s[44:47], s58 offen nt
  s_add_u32 s58, s58, 4096
  v_dot2_f32_bf16 v18, v152, v2, 0
  v_permlane16_swap_b32 v20, v21
  v_dot2_f32_bf16 v18, v153, v3, v18
  v_dot2_f32_bf16 v18, v154, v4, v18
  v_add_f32 v20, v20, v21
  v_dot2_f32_bf16 v18, v155, v5, v18
  s_waitcnt lgkmcnt(0)
  v_cmp_le_i32 vcc, 40, v0
  s_cbranch_vccnz L_em78
  s_waitcnt vmcnt(3)
L_em78:
  s_waitcnt vmcnt(5)
  buffer_load_dwordx4 v[52:55], v1, s[44:47], s58 offen nt
  s_add_u32 s58, s58, 4096
  v_dot2_f32_bf16 v19, v156, v2, 0
  v_add_f32_dpp v22, v20, v20 row_ror:8 row_mask:0xf bank_mask:0xc
  v_dot2_f32_bf16 v19, v157, v3, v19
  v_dot2_f32_bf16 v19, v158, v4, v19
  v_add_f32_dpp v23, v22, v22 row_half_mirror row_mask:0xf bank_mask:0xf
  v_dot2_f32_bf16 v19, v159, v5, v19
  ds_read_b32 v0, v35 offset:4688
  s_cbranch_vccnz L_em79
  s_waitcnt vmcnt(3)
L_em79:
  s_waitcnt vmcnt(5)
  buffer_load_dwordx4 v[56:59], v1, s[44:47], s58 offen nt
  s_add_u32 s58, s58, 4096
  v_dot2_f32_bf16 v20, v160, v2, 0
  v_permlane16_swap_b32 v18, v19
  v_dot2_f32_bf16 v20, v161, v3, v20
  v_dot2_f32_bf16 v20, v162, v4, v20
  v_add_f32 v18, v18, v19
  v_dot2_f32_bf16 v20, v163, v5, v20
  s_cbranch_vccnz L_em80
  s_waitcnt vmcnt(3)
L_em80:
  s_waitcnt vmcnt(5)
  buffer_load_dwordx4 v[60:63], v1, s[44:47], s58 offen nt
  s_add_u32 s58, s58, 4096
  v_dot2_f32_bf16 v21, v164, v2, 0
  v_add_f32_dpp v22, v18, v18 row_ror:8 row_mask:0xf bank_mask:0xf
  v_dot2_f32_bf16 v21, v165, v3, v21
  v_dot2_f32_bf16 v21, v166, v4, v21
  v_dot2_f32_bf16 v21, v167, v5, v21
  s_waitcnt lgkmcnt(0)
  v_cmp_le_i32 vcc, 56, v0
  s_nop 0
  v_permlane16_swap_b32 v20, v21
  v_add_f32 v20, v20, v21
  s_nop 1
  v_add_f32_dpp v22, v20, v20 row_ror:8 row_mask:0xf bank_mask:0xc
  s_nop 1
  v_add_f32_dpp v23, v22, v22 row_half_mirror row_mask:0xf bank_mask:0xa
  s_nop 1
  v_add_f32_dpp v25, v23, v23 quad_perm:[2,3,0,1] row_mask:0xf bank_mask:0xf
  v_cndmask_b32 v24, v24, v25, s[60:61]
  s_nop 1
  v_add_f32_dpp v27, v24, v24 quad_perm:[1,0,3,2] row_mask:0xf bank_mask:0xf
  v_cndmask_b32 v26, v26, v27, s[62:63]
  v_cvt_pk_bf16_f32 v26, v26, v26
  v_lshlrev_b32 v17, 16, v26
  v_max_f32 v34, v34, v17
  ds_add_u32 v35, v1 offset:4672
  s_cbranch_vccnz L_em81
  s_waitcnt vmcnt(3)
L_em81:
  s_waitcnt vmcnt(5)
  buffer_load_dwordx4 v[64:67], v1, s[44:47], s58 offen nt
  s_add_u32 s58, s58, 4096
  v_max_f32_dpp v34, v34, v34 row_ror:8 row_mask:0xf bank_mask:0xf
  s_nop 1
  v_max_f32_dpp v34, v34, v34 row_ror:4 row_mask:0xf bank_mask:0xf
  s_nop 1
  v_max_f32_dpp v34, v34, v34 row_ror:2 row_mask:0xf bank_mask:0xf
  s_nop 1
  v_max_f32_dpp v34, v34, v34 row_ror:1 row_mask:0xf bank_mask:0xf
  v_mov_b32 v18, v34
  s_nop 1
  v_permlane16_swap_b32 v34, v18
  v_max_f32 v34, v34, v18
  v_mov_b32 v18, v34
  s_nop 1
  v_permlane32_swap_b32 v34, v18
  v_max_f32 v34, v34, v18
  v_mov_b32 v19, 0x3db8aa3b
  v_mul_f32 v20, v34, v19
  v_fma_f32 v10, v10, v19, -v20
  v_fma_f32 v11, v11, v19, -v20
  v_fma_f32 v12, v12, v19, -v20
  v_fma_f32 v13, v13, v19, -v20
  v_fma_f32 v14, v14, v19, -v20
  v_fma_f32 v15, v15, v19, -v20
  v_fma_f32 v16, v16, v19, -v20
  v_fma_f32 v17, v17, v19, -v20
  v_exp_f32 v10, v10
  v_exp_f32 v11, v11
  v_exp_f32 v12, v12
  v_exp_f32 v13, v13
  v_exp_f32 v14, v14
  v_exp_f32 v15, v15
  v_exp_f32 v16, v16
  v_exp_f32 v17, v17
  s_cbranch_vccnz L_em82
  s_waitcnt vmcnt(3)
L_em82:
  s_waitcnt vmcnt(5)
  buffer_load_dwordx4 v[68:71], v1, s[44:47], s58 offen nt
  s_add_u32 s58, s58, 4096
  v_add_f32 v36, v10, v11
  v_add_f32 v36, v36, v12
  v_add_f32 v36, v36, v13
  v_add_f32 v36, v36, v14
  v_add_f32 v36, v36, v15
  v_add_f32 v36, v36, v16
  v_add_f32 v36, v36, v17
  v_mov_b32 v18, v10
  v_mov_b32 v19, v11
  v_mov_b32 v20, v12
  v_mov_b32 v21, v13
  v_mov_b32 v22, v14
  v_mov_b32 v23, v15
  v_mov_b32 v24, v16
  v_mov_b32 v25, v17
  v_permlane32_swap_b32 v10, v18
  v_permlane32_swap_b32 v11, v19
  v_permlane32_swap_b32 v12, v20
  v_permlane32_swap_b32 v13, v21
  v_permlane32_swap_b32 v14, v22
  v_permlane32_swap_b32 v15, v23
  v_permlane32_swap_b32 v16, v24
  v_permlane32_swap_b32 v17, v25
  v_cvt_pk_bf16_f32 v10, v10, v18
  v_cvt_pk_bf16_f32 v11, v11, v19
  v_cvt_pk_bf16_f32 v12, v12, v20
  v_cvt_pk_bf16_f32 v13, v13, v21
  v_cvt_pk_bf16_f32 v14, v14, v22
  v_cvt_pk_bf16_f32 v15, v15, v23
  v_cvt_pk_bf16_f32 v16, v16, v24
  v_cvt_pk_bf16_f32 v17, v17, v25
  s_cbranch_vccnz L_em83
  s_waitcnt vmcnt(3)
L_em83:
  s_waitcnt vmcnt(5)
  buffer_load_dwordx4 v[72:75], v1, s[44:47], s58 offen nt
  s_add_u32 s58, s58, 4096
  v_add_f32_dpp v36, v36, v36 row_ror:8 row_mask:0xf bank_mask:0xf
  s_nop 1
  v_add_f32_dpp v36, v36, v36 row_ror:4 row_mask:0xf bank_mask:0xf
  s_nop 1
  v_add_f32_dpp v36, v36, v36 row_ror:2 row_mask:0xf bank_mask:0xf
  s_nop 1
  v_add_f32_dpp v36, v36, v36 row_ror:1 row_mask:0xf bank_mask:0xf
  v_mov_b32 v18, v36
  s_nop 1
  v_permlane16_swap_b32 v36, v18
  v_add_f32 v36, v36, v18
  v_mov_b32 v18, v36
  s_nop 1
  v_permlane32_swap_b32 v36, v18
  v_add_f32 v36, v36, v18
  v_add_u32 v18, 4608, v35
  ds_write2_b32 v18, v34, v36 offset0:0 offset1:4
  v_readlane_b32 s64, v10, 0
  v_readlane_b32 s65, v10, 16
  v_mov_b32 v26, 0
  v_mov_b32 v27, 0
  v_mov_b32 v28, 0
  v_mov_b32 v29, 0
  v_mov_b32 v30, 0
  v_mov_b32 v31, 0
  v_mov_b32 v32, 0
  v_mov_b32 v33, 0
  v_perm_b32 v18, s64, s64, v6
  v_perm_b32 v19, s64, s64, v7
  v_perm_b32 v20, s64, s64, v8
  v_perm_b32 v21, s64, s64, v9
  v_mov_b32 v36, 1
  v_mov_b32 v34, 0
  s_mov_b32 s59, 0
  s_nop 0
L_vloop:
  v_readlane_b32 s64, v10, 8
  v_perm_b32 v22, s65, s65, v6
  v_perm_b32 v23, s65, s65, v7
  v_perm_b32 v24, s65, s65, v8
  v_perm_b32 v25, s65, s65, v9
  v_mfma_f32_16x16x32_bf16 v[26:29], v[18:21], v[40:43], v[26:29]
  s_cbranch_vccnz L_em84
  s_waitcnt vmcnt(3)
L_em84:
  s_waitcnt vmcnt(5)
  buffer_load_dwordx4 v[76:79], v1, s[44:47], s58 offen nt
  s_add_u32 s58, s58, 4096
  v_readlane_b32 s65, v10, 24
  v_perm_b32 v18, s64, s64, v6
  v_perm_b32 v19, s64, s64, v7
  v_perm_b32 v20, s64, s64, v8
  v_perm_b32 v21, s64, s64, v9
  v_mfma_f32_16x16x32_bf16 v[30:33], v[22:25], v[44:47], v[30:33]
  s_cbranch_vccnz L_em85
  s_waitcnt vmcnt(3)
L_em85:
  s_waitcnt vmcnt(5)
  buffer_load_dwordx4 v[80:83], v1, s[44:47], s58 offen nt
  s_add_u32 s58, s58, 4096
  v_readlane_b32 s64, v10, 4
  v_perm_b32 v22, s65, s65, v6
  v_perm_b32 v23, s65, s65, v7
  v_perm_b32 v24, s65, s65, v8
  v_perm_b32 v25, s65, s65, v9
  v_mfma_f32_16x16x32_bf16 v[26:29], v[18:21], v[48:51], v[26:29]
  ds_read_b32 v0, v35 offset:4688
  s_cbranch_vccnz L_em86
  s_waitcnt vmcnt(3)
L_em86:
  s_waitcnt vmcnt(5)
  buffer_load_dwordx4 v[84:87], v1, s[44:47], s58 offen nt
  s_add_u32 s58, s58, 4096
  v_readlane_b32 s65, v10, 20
  v_perm_b32 v18, s64, s64, v6
  v_perm_b32 v19, s64, s64, v7
  v_perm_b32 v20, s64, s64, v8
  v_perm_b32 v21, s64, s64, v9
  v_mfma_f32_16x16x32_bf16 v[30:33], v[22:25], v[52:55], v[30:33]
  s_cbranch_vccnz L_em87
  s_waitcnt vmcnt(3)
L_em87:
  s_waitcnt vmcnt(5)
  buffer_load_dwordx4 v[88:91], v1, s[44:47], s58 offen nt
  s_add_u32 s58, s58, 4096
  v_readlane_b32 s64, v10, 12
  v_perm_b32 v22, s65, s65, v6
  v_perm_b32 v23, s65, s65, v7
  v_perm_b32 v24, s65, s65, v8
  v_perm_b32 v25, s65, s65, v9
  v_mfma_f32_16x16x32_bf16 v[26:29], v[18:21], v[56:59], v[26:29]
  s_waitcnt lgkmcnt(0)
  v_cmp_le_i32 vcc, 32, v0
  s_cbranch_vccnz L_em88
  s_waitcnt vmcnt(3)
L_em88:
  s_waitcnt vmcnt(5)
  buffer_load_dwordx4 v[92:95], v1, s[44:47], s58 offen nt
  s_add_u32 s58, s58, 4096
  v_readlane_b32 s65, v10, 28
  v_perm_b32 v18, s64, s64, v6
  v_perm_b32 v19, s64, s64, v7
  v_perm_b32 v20, s64, s64, v8
  v_perm_b32 v21, s64, s64, v9
  v_mfma_f32_16x16x32_bf16 v[30:33], v[22:25], v[60:63], v[30:33]
  s_cbranch_vccnz L_em89
  s_waitcnt vmcnt(3)
L_em89:
  s_waitcnt vmcnt(5)
  buffer_load_dwordx4 v[96:99], v1, s[44:47], s58 offen nt
  s_add_u32 s58, s58, 4096
  v_readlane_b32 s64, v10, 2
  v_perm_b32 v22, s65, s65, v6
  v_perm_b32 v23, s65, s65, v7
  v_perm_b32 v24, s65, s65, v8
  v_perm_b32 v25, s65, s65, v9
  v_mfma_f32_16x16x32_bf16 v[26:29], v[18:21], v[64:67], v[26:29]
  ds_read_b32 v0, v35 offset:4688
  s_cbranch_vccnz L_em90
  s_waitcnt vmcnt(3)
L_em90:
  s_waitcnt vmcnt(5)
  buffer_load_dwordx4 v[100:103], v1, s[44:47], s58 offen nt
  s_add_u32 s58, s58, 4096
  v_readlane_b32 s65, v10, 18
  v_perm_b32 v18, s64, s64, v6
  v_perm_b32 v19, s64, s64, v7
  v_perm_b32 v20, s64, s64, v8
  v_perm_b32 v21, s64, s64, v9
  v_mfma_f32_16x16x32_bf16 v[30:33], v[22:25], v[68:71], v[30:33]
  s_cbranch_vccnz L_em91
  s_waitcnt vmcnt(3)
L_em91:
  s_waitcnt vmcnt(5)
  buffer_load_dwordx4 v[104:107], v1, s[44:47], s58 offen nt
  s_add_u32 s58, s58, 4096
  v_readlane_b32 s64, v10, 10
  v_perm_b32 v22, s65, s65, v6
  v_perm_b32 v23, s65, s65, v7
  v_perm_b32 v24, s65, s65, v8
  v_perm_b32 v25, s65, s65, v9
  v_mfma_f32_16x16x32_bf16 v[26:29], v[18:21], v[72:75], v[26:29]
  s_waitcnt lgkmcnt(0)
  v_cmp_le_i32 vcc, 48, v0
  s_cbranch_vccnz L_em92
  s_waitcnt vmcnt(3)
L_em92:
  s_waitcnt vmcnt(5)
  buffer_load_dwordx4 v[108:111], v1, s[44:47], s58 offen nt
  s_add_u32 s58, s58, 4096
  v_readlane_b32 s65, v10, 26
  v_perm_b32 v18, s64, s64, v6
  v_perm_b32 v19, s64, s64, v7
  v_perm_b32 v20, s64, s64, v8
  v_perm_b32 v21, s64, s64, v9
  v_mfma_f32_16x16x32_bf16 v[30:33], v[22:25], v[76:79], v[30:33]
  s_cbranch_vccnz L_em93
  s_waitcnt vmcnt(3)
L_em93:
  s_waitcnt vmcnt(5)
  buffer_load_dwordx4 v[112:115], v1, s[44:47], s58 offen nt
  s_add_u32 s58, s58, 4096
  v_readlane_b32 s64, v10, 6
  v_perm_b32 v22, s65, s65, v6
  v_perm_b32 v23, s65, s65, v7
  v_perm_b32 v24, s65, s65, v8
  v_perm_b32 v25, s65, s65, v9
  v_mfma_f32_16x16x32_bf16 v[26:29], v[18:21], v[80:83], v[26:29]
  ds_read_b32 v0, v35 offset:4688
  s_cbranch_vccnz L_em94
  s_waitcnt vmcnt(3)
L_em94:
  s_waitcnt vmcnt(5)
  buffer_load_dwordx4 v[116:119], v1, s[44:47], s58 offen nt
  s_add_u32 s58, s58, 4096
  v_readlane_b32 s65, v10, 22
  v_perm_b32 v18, s64, s64, v6
  v_perm_b32 v19, s64, s64, v7
  v_perm_b32 v20, s64, s64, v8
  v_perm_b32 v21, s64, s64, v9
  v_mfma_f32_16x16x32_bf16 v[30:33], v[22:25], v[84:87], v[30:33]
  s_cbranch_vccnz L_em95
  s_waitcnt vmcnt(3)
L_em95:
  s_waitcnt vmcnt(5)
  buffer_load_dwordx4 v[120:123], v1, s[44:47], s58 offen nt
  s_add_u32 s58, s58, 4096
  v_readlane_b32 s64, v10, 14
  v_perm_b32 v22, s65, s65, v6
  v_perm_b32 v23, s65, s65, v7
  v_perm_b32 v24, s65, s65, v8
  v_perm_b32 v25, s65, s65, v9
  v_mfma_f32_16x16x32_bf16 v[26:29], v[18:21], v[88:91], v[26:29]
  s_waitcnt lgkmcnt(0)
  v_cmp_le_i32 vcc, 40, v0
  s_cbranch_vccnz L_em96
  s_waitcnt vmcnt(3)
L_em96:
  s_waitcnt vmcnt(5)
  buffer_load_dwordx4 v[124:127], v1, s[44:47], s58 offen nt
  s_add_u32 s58, s58, 4096
  v_readlane_b32 s65, v10, 30
  v_perm_b32 v18, s64, s64, v6
  v_perm_b32 v19, s64, s64, v7
  v_perm_b32 v20, s64, s64, v8
  v_perm_b32 v21, s64, s64, v9
  v_mfma_f32_16x16x32_bf16 v[30:33], v[22:25], v[92:95], v[30:33]
  s_cbranch_vccnz L_em97
  s_waitcnt vmcnt(3)
L_em97:
  s_waitcnt vmcnt(5)
  buffer_load_dwordx4 v[128:131], v1, s[44:47], s58 offen nt
  s_add_u32 s58, s58, 4096
  v_readlane_b32 s64, v10, 1
  v_perm_b32 v22, s65, s65, v6
  v_perm_b32 v23, s65, s65, v7
  v_perm_b32 v24, s65, s65, v8
  v_perm_b32 v25, s65, s65, v9
  v_mfma_f32_16x16x32_bf16 v[26:29], v[18:21], v[96:99], v[26:29]
  ds_read_b32 v0, v35 offset:4688
  s_cbranch_vccnz L_em98
  s_waitcnt vmcnt(3)
L_em98:
  s_waitcnt vmcnt(5)
  buffer_load_dwordx4 v[132:135], v1, s[44:47], s58 offen nt
  s_add_u32 s58, s58, 4096
  v_readlane_b32 s65, v10, 17
  v_perm_b32 v18, s64, s64, v6
  v_perm_b32 v19, s64, s64, v7
  v_perm_b32 v20, s64, s64, v8
  v_perm_b32 v21, s64, s64, v9
  v_mfma_f32_16x16x32_bf16 v[30:33], v[22:25], v[100:103], v[30:33]
  ds_add_u32 v35, v1 offset:4672
  s_cbranch_vccnz L_em99
  s_waitcnt vmcnt(3)
L_em99:
  s_waitcnt vmcnt(5)
  buffer_load_dwordx4 v[136:139], v1, s[44:47], s58 offen nt
  s_add_u32 s58, s58, 4096
  v_readlane_b32 s64, v10, 9
  v_perm_b32 v22, s65, s65, v6
  v_perm_b32 v23, s65, s65, v7
  v_perm_b32 v24, s65, s65, v8
  v_perm_b32 v25, s65, s65, v9
  v_mfma_f32_16x16x32_bf16 v[26:29], v[18:21], v[104:107], v[26:29]
  s_waitcnt lgkmcnt(0)
  v_cmp_le_i32 vcc, 56, v0
  s_cbranch_vccnz L_em100
  s_waitcnt vmcnt(3)
L_em100:
  s_waitcnt vmcnt(5)
  buffer_load_dwordx4 v[140:143], v1, s[44:47], s58 offen nt
  s_add_u32 s58, s58, 4096
  v_readlane_b32 s65, v10, 25
  v_perm_b32 v18, s64, s64, v6
  v_perm_b32 v19, s64, s64, v7
  v_perm_b32 v20, s64, s64, v8
  v_perm_b32 v21, s64, s64, v9
  v_mfma_f32_16x16x32_bf16 v[30:33], v[22:25], v[108:111], v[30:33]
  s_cbranch_vccnz L_em101
  s_waitcnt vmcnt(3)
L_em101:
  s_waitcnt vmcnt(5)
  buffer_load_dwordx4 v[144:147], v1, s[44:47], s58 offen nt
  s_add_u32 s58, s58, 4096
  v_readlane_b32 s64, v10, 5
  v_perm_b32 v22, s65, s65, v6
  v_perm_b32 v23, s65, s65, v7
  v_perm_b32 v24, s65, s65, v8
  v_perm_b32 v25, s65, s65, v9
  v_mfma_f32_16x16x32_bf16 v[26:29], v[18:21], v[112:115], v[26:29]
  ds_read_b32 v0, v35 offset:4688
  s_cbranch_vccnz L_em102
  s_waitcnt vmcnt(3)
L_em102:
  s_waitcnt vmcnt(5)
  buffer_load_dwordx4 v[148:151], v1, s[44:47], s58 offen nt
  s_add_u32 s58, s58, 4096
  v_readlane_b32 s65, v10, 21
  v_perm_b32 v18, s64, s64, v6
  v_perm_b32 v19, s64, s64, v7
  v_perm_b32 v20, s64, s64, v8
  v_perm_b32 v21, s64, s64, v9
  v_mfma_f32_16x16x32_bf16 v[30:33], v[22:25], v[116:119], v[30:33]
  s_cbranch_vccnz L_em103
  s_waitcnt vmcnt(3)
L_em103:
  s_waitcnt vmcnt(5)
  buffer_load_dwordx4 v[152:155], v1, s[44:47], s58 offen nt
  s_add_u32 s58, s58, 4096
  v_readlane_b32 s64, v10, 13
  v_perm_b32 v22, s65, s65, v6
  v_perm_b32 v23, s65, s65, v7
  v_perm_b32 v24, s65, s65, v8
  v_perm_b32 v25, s65, s65, v9
  v_mfma_f32_16x16x32_bf16 v[26:29], v[18:21], v[120:123], v[26:29]
  s_waitcnt lgkmcnt(0)
  v_cmp_le_i32 vcc, 32, v0
  s_cbranch_vccnz L_em104
  s_waitcnt vmcnt(3)
L_em104:
  s_waitcnt vmcnt(5)
  buffer_load_dwordx4 v[156:159], v1, s[44:47], s58 offen nt
  s_add_u32 s58, s58, 4096
  v_readlane_b32 s65, v10, 29
  v_perm_b32 v18, s64, s64, v6
  v_perm_b32 v19, s64, s64, v7
  v_perm_b32 v20, s64, s64, v8
  v_perm_b32 v21, s64, s64, v9
  v_mfma_f32_16x16x32_bf16 v[30:33], v[22:25], v[124:127], v[30:33]
  s_cbranch_vccnz L_em105
  s_waitcnt vmcnt(3)
L_em105:
  s_waitcnt vmcnt(5)
  buffer_load_dwordx4 v[160:163], v1, s[44:47], s58 offen nt
  s_add_u32 s58, s58, 4096
  v_readlane_b32 s64, v10, 3
  v_perm_b32 v22, s65, s65, v6
  v_perm_b32 v23, s65, s65, v7
  v_perm_b32 v24, s65, s65, v8
  v_perm_b32 v25, s65, s65, v9
  v_mfma_f32_16x16x32_bf16 v[26:29], v[18:21], v[128:131], v[26:29]
  ds_read_b32 v0, v35 offset:4688
  s_cbranch_vccnz L_em106
  s_waitcnt vmcnt(3)
L_em106:
  s_waitcnt vmcnt(5)
  buffer_load_dwordx4 v[164:167], v1, s[44:47], s58 offen nt
  s_add_u32 s58, s58, 4096
  v_readlane_b32 s65, v10, 19
  v_perm_b32 v18, s64, s64, v6
  v_perm_b32 v19, s64, s64, v7
  v_perm_b32 v20, s64, s64, v8
  v_perm_b32 v21, s64, s64, v9
  v_mfma_f32_16x16x32_bf16 v[30:33], v[22:25], v[132:135], v[30:33]
  s_cbranch_vccnz L_em107
  s_waitcnt vmcnt(3)
L_em107:
  s_waitcnt vmcnt(5)
  buffer_load_dwordx4 v[40:43], v1, s[44:47], s58 offen nt
  s_add_u32 s58, s58, 4096
  v_readlane_b32 s64, v10, 11
  v_perm_b32 v22, s65, s65, v6
  v_perm_b32 v23, s65, s65, v7
  v_perm_b32 v24, s65, s65, v8
  v_perm_b32 v25, s65, s65, v9
  v_mfma_f32_16x16x32_bf16 v[26:29], v[18:21], v[136:139], v[26:29]
  s_waitcnt lgkmcnt(0)
  v_cmp_le_i32 vcc, 48, v0
  s_cbranch_vccnz L_em108
  s_waitcnt vmcnt(3)
L_em108:
  s_waitcnt vmcnt(5)
  buffer_load_dwordx4 v[44:47], v1, s[44:47], s58 offen nt
  s_add_u32 s58, s58, 4096
  v_readlane_b32 s65, v10, 27
  v_perm_b32 v18, s64, s64, v6
  v_perm_b32 v19, s64, s64, v7
  v_perm_b32 v20, s64, s64, v8
  v_perm_b32 v21, s64, s64, v9
  v_mfma_f32_16x16x32_bf16 v[30:33], v[22:25], v[140:143], v[30:33]
  s_cbranch_vccnz L_em109
  s_waitcnt vmcnt(3)
L_em109:
  s_waitcnt vmcnt(5)
  buffer_load_dwordx4 v[48:51], v1, s[44:47], s58 offen nt
  s_add_u32 s58, s58, 4096
  v_readlane_b32 s64, v10, 7
  v_perm_b32 v22, s65, s65, v6
  v_perm_b32 v23, s65, s65, v7
  v_perm_b32 v24, s65, s65, v8
  v_perm_b32 v25, s65, s65, v9
  v_mfma_f32_16x16x32_bf16 v[26:29], v[18:21], v[144:147], v[26:29]
  ds_read_b32 v0, v35 offset:4688
  s_cbranch_vccnz L_em110
  s_waitcnt vmcnt(3)
L_em110:
  s_waitcnt vmcnt(5)
  buffer_load_dwordx4 v[52:55], v1, s[44:47], s58 offen nt
  s_add_u32 s58, s58, 4096
  v_readlane_b32 s65, v10, 23
  v_perm_b32 v18, s64, s64, v6
  v_perm_b32 v19, s64, s64, v7
  v_perm_b32 v20, s64, s64, v8
  v_perm_b32 v21, s64, s64, v9
  v_mfma_f32_16x16x32_bf16 v[30:33], v[22:25], v[148:151], v[30:33]
  s_cbranch_vccnz L_em111
  s_waitcnt vmcnt(3)
L_em111:
  s_waitcnt vmcnt(5)
  buffer_load_dwordx4 v[56:59], v1, s[44:47], s58 offen nt
  s_add_u32 s58, s58, 4096
  v_readlane_b32 s64, v10, 15
  v_perm_b32 v22, s65, s65, v6
  v_perm_b32 v23, s65, s65, v7
  v_perm_b32 v24, s65, s65, v8
  v_perm_b32 v25, s65, s65, v9
  v_mfma_f32_16x16x32_bf16 v[26:29], v[18:21], v[152:155], v[26:29]
  s_waitcnt lgkmcnt(0)
  v_cmp_le_i32 vcc, 40, v0
  s_cbranch_vccnz L_em112
  s_waitcnt vmcnt(3)
L_em112:
  s_waitcnt vmcnt(5)
  buffer_load_dwordx4 v[60:63], v1, s[44:47], s58 offen nt
  s_add_u32 s58, s58, 4096
  v_readlane_b32 s65, v10, 31
  v_perm_b32 v18, s64, s64, v6
  v_perm_b32 v19, s64, s64, v7
  v_perm_b32 v20, s64, s64, v8
  v_perm_b32 v21, s64, s64, v9
  v_mfma_f32_16x16x32_bf16 v[30:33], v[22:25], v[156:159], v[30:33]
  ds_read_b32 v0, v35 offset:4688
  s_cbranch_vccnz L_em113
  s_waitcnt vmcnt(3)
L_em113:
  s_waitcnt vmcnt(5)
  buffer_load_dwordx4 v[64:67], v1, s[44:47], s58 offen nt
  s_add_u32 s58, s58, 4096
  v_readlane_b32 s64, v11, 0
  v_perm_b32 v22, s65, s65, v6
  v_perm_b32 v23, s65, s65, v7
  v_perm_b32 v24, s65, s65, v8
  v_perm_b32 v25, s65, s65, v9
  v_mfma_f32_16x16x32_bf16 v[26:29], v[18:21], v[160:163], v[26:29]
  s_cbranch_vccnz L_em114
  s_waitcnt vmcnt(3)
L_em114:
  s_waitcnt vmcnt(5)
  buffer_load_dwordx4 v[68:71], v1, s[44:47], s58 offen nt
  s_add_u32 s58, s58, 4096
  v_readlane_b32 s65, v11, 16
  v_perm_b32 v18, s64, s64, v6
  v_perm_b32 v19, s64, s64, v7
  v_perm_b32 v20, s64, s64, v8
  v_perm_b32 v21, s64, s64, v9
  v_mfma_f32_16x16x32_bf16 v[30:33], v[22:25], v[164:167], v[30:33]
  s_waitcnt lgkmcnt(0)
  v_cmp_le_i32 vcc, 56, v0
  s_add_u32 s59, s59, 1
  v_mov_b32 v10, v11
  v_mov_b32 v11, v12
  v_mov_b32 v12, v13
  v_mov_b32 v13, v14
  v_mov_b32 v14, v15
  v_mov_b32 v15, v16
  v_mov_b32 v16, v17
  ds_add_u32 v35, v1 offset:4672
  s_cbranch_vccnz L_em115
  s_waitcnt vmcnt(3)
L_em115:
  s_waitcnt vmcnt(5)
  buffer_load_dwordx4 v[72:75], v1, s[44:47], s58 offen nt
  s_add_u32 s58, s58, 4096
  s_cmp_lt_u32 s59, 7
  s_cbranch_scc1 L_vloop
  v_readlane_b32 s64, v10, 8
  v_perm_b32 v22, s65, s65, v6
  v_perm_b32 v23, s65, s65, v7
  v_perm_b32 v24, s65, s65, v8
  v_perm_b32 v25, s65, s65, v9
  v_mfma_f32_16x16x32_bf16 v[26:29], v[18:21], v[40:43], v[26:29]
  s_cbranch_vccnz L_em116
  s_waitcnt vmcnt(3)
L_em116:
  s_waitcnt vmcnt(5)
  buffer_load_dwordx4 v[76:79], v1, s[44:47], s58 offen nt
  s_add_u32 s58, s58, 4096
  v_readlane_b32 s65, v10, 24
  v_perm_b32 v18, s64, s64, v6
  v_perm_b32 v19, s64, s64, v7
  v_perm_b32 v20, s64, s64, v8
  v_perm_b32 v21, s64, s64, v9
  v_mfma_f32_16x16x32_bf16 v[30:33], v[22:25], v[44:47], v[30:33]
  s_cbranch_vccnz L_em117
  s_waitcnt vmcnt(3)
L_em117:
  s_waitcnt vmcnt(5)
  buffer_load_dwordx4 v[80:83], v1, s[44:47], s58 offen nt
  s_add_u32 s58, s58, 4096
  v_readlane_b32 s64, v10, 4
  v_perm_b32 v22, s65, s65, v6
  v_perm_b32 v23, s65, s65, v7
  v_perm_b32 v24, s65, s65, v8
  v_perm_b32 v25, s65, s65, v9
  v_mfma_f32_16x16x32_bf16 v[26:29], v[18:21], v[48:51], v[26:29]
  ds_read_b32 v0, v35 offset:4688
  s_cbranch_vccnz L_em118
  s_waitcnt vmcnt(3)
L_em118:
  s_waitcnt vmcnt(5)
  buffer_load_dwordx4 v[84:87], v1, s[44:47], s58 offen nt
  s_add_u32 s58, s58, 4096
  v_readlane_b32 s65, v10, 20
  v_perm_b32 v18, s64, s64, v6
  v_perm_b32 v19, s64, s64, v7
  v_perm_b32 v20, s64, s64, v8
  v_perm_b32 v21, s64, s64, v9
  v_mfma_f32_16x16x32_bf16 v[30:33], v[22:25], v[52:55], v[30:33]
  s_cbranch_vccnz L_em119
  s_waitcnt vmcnt(3)
L_em119:
  s_waitcnt vmcnt(5)
  buffer_load_dwordx4 v[88:91], v1, s[44:47], s58 offen nt
  s_add_u32 s58, s58, 4096
  v_readlane_b32 s64, v10, 12
  v_perm_b32 v22, s65, s65, v6
  v_perm_b32 v23, s65, s65, v7
  v_perm_b32 v24, s65, s65, v8
  v_perm_b32 v25, s65, s65, v9
  v_mfma_f32_16x16x32_bf16 v[26:29], v[18:21], v[56:59], v[26:29]
  s_waitcnt lgkmcnt(0)
  v_cmp_le_i32 vcc, 32, v0
  s_cbranch_vccnz L_em120
  s_waitcnt vmcnt(3)
L_em120:
  s_waitcnt vmcnt(5)
  buffer_load_dwordx4 v[92:95], v1, s[44:47], s58 offen nt
  s_add_u32 s58, s58, 4096
  v_readlane_b32 s65, v10, 28
  v_perm_b32 v18, s64, s64, v6
  v_perm_b32 v19, s64, s64, v7
  v_perm_b32 v20, s64, s64, v8
  v_perm_b32 v21, s64, s64, v9
  v_mfma_f32_16x16x32_bf16 v[30:33], v[22:25], v[60:63], v[30:33]
  s_cbranch_vccnz L_em121
  s_waitcnt vmcnt(3)
L_em121:
  s_waitcnt vmcnt(5)
  buffer_load_dwordx4 v[96:99], v1, s[44:47], s58 offen nt
  s_add_u32 s58, s58, 4096
  v_readlane_b32 s64, v10, 2
  v_perm_b32 v22, s65, s65, v6
  v_perm_b32 v23, s65, s65, v7
  v_perm_b32 v24, s65, s65, v8
  v_perm_b32 v25, s65, s65, v9
  v_mfma_f32_16x16x32_bf16 v[26:29], v[18:21], v[64:67], v[26:29]
  ds_read_b32 v0, v35 offset:4688
  s_cbranch_vccnz L_em122
  s_waitcnt vmcnt(3)
L_em122:
  s_waitcnt vmcnt(5)
  buffer_load_dwordx4 v[100:103], v1, s[44:47], s58 offen nt
  s_add_u32 s58, s58, 4096
  v_readlane_b32 s65, v10, 18
  v_perm_b32 v18, s64, s64, v6
  v_perm_b32 v19, s64, s64, v7
  v_perm_b32 v20, s64, s64, v8
  v_perm_b32 v21, s64, s64, v9
  v_mfma_f32_16x16x32_bf16 v[30:33], v[22:25], v[68:71], v[30:33]
  s_cbranch_vccnz L_em123
  s_waitcnt vmcnt(3)
L_em123:
  s_waitcnt vmcnt(5)
  buffer_load_dwordx4 v[104:107], v1, s[44:47], s58 offen nt
  s_add_u32 s58, s58, 4096
  v_readlane_b32 s64, v10, 10
  v_perm_b32 v22, s65, s65, v6
  v_perm_b32 v23, s65, s65, v7
  v_perm_b32 v24, s65, s65, v8
  v_perm_b32 v25, s65, s65, v9
  v_mfma_f32_16x16x32_bf16 v[26:29], v[18:21], v[72:75], v[26:29]
  s_waitcnt lgkmcnt(0)
  v_cmp_le_i32 vcc, 48, v0
  s_cbranch_vccnz L_em124
  s_waitcnt vmcnt(3)
L_em124:
  s_waitcnt vmcnt(5)
  buffer_load_dwordx4 v[108:111], v1, s[44:47], s58 offen nt
  s_add_u32 s58, s58, 4096
  v_readlane_b32 s65, v10, 26
  v_perm_b32 v18, s64, s64, v6
  v_perm_b32 v19, s64, s64, v7
  v_perm_b32 v20, s64, s64, v8
  v_perm_b32 v21, s64, s64, v9
  v_mfma_f32_16x16x32_bf16 v[30:33], v[22:25], v[76:79], v[30:33]
  s_cbranch_vccnz L_em125
  s_waitcnt vmcnt(3)
L_em125:
  s_waitcnt vmcnt(5)
  buffer_load_dwordx4 v[112:115], v1, s[44:47], s58 offen nt
  s_add_u32 s58, s58, 4096
  v_readlane_b32 s64, v10, 6
  v_perm_b32 v22, s65, s65, v6
  v_perm_b32 v23, s65, s65, v7
  v_perm_b32 v24, s65, s65, v8
  v_perm_b32 v25, s65, s65, v9
  v_mfma_f32_16x16x32_bf16 v[26:29], v[18:21], v[80:83], v[26:29]
  ds_read_b32 v0, v35 offset:4688
  s_cbranch_vccnz L_em126
  s_waitcnt vmcnt(3)
L_em126:
  s_waitcnt vmcnt(5)
  buffer_load_dwordx4 v[116:119], v1, s[44:47], s58 offen nt
  s_add_u32 s58, s58, 4096
  buffer_load_dwordx4 v[120:123], v1, s[44:47], s58 offen nt
  s_add_u32 s58, s58, 4096
  buffer_load_dwordx4 v[124:127], v1, s[44:47], s58 offen nt
  s_add_u32 s58, s58, 4096
  buffer_load_dwordx4 v[128:131], v1, s[44:47], s58 offen nt
  s_add_u32 s58, s58, 4096
  buffer_load_dwordx4 v[132:135], v1, s[44:47], s58 offen nt
  s_add_u32 s58, s58, 4096
  buffer_load_dwordx4 v[136:139], v1, s[44:47], s58 offen nt
  s_add_u32 s58, s58, 4096
  buffer_load_dwordx4 v[140:143], v1, s[44:47], s58 offen nt
  s_add_u32 s58, s58, 4096
  buffer_load_dwordx4 v[144:147], v1, s[44:47], s58 offen nt
  s_add_u32 s58, s58, 4096
  buffer_load_dwordx4 v[148:151], v1, s[44:47], s58 offen nt
  s_add_u32 s58, s58, 4096
  buffer_load_dwordx4 v[152:155], v1, s[44:47], s58 offen nt
  s_add_u32 s58, s58, 4096
  buffer_load_dwordx4 v[156:159], v1, s[44:47], s58 offen nt
  s_add_u32 s58, s58, 4096
  buffer_load_dwordx4 v[160:163], v1, s[44:47], s58 offen nt
  s_add_u32 s58, s58, 4096
  buffer_load_dwordx4 v[164:167], v1, s[44:47], s58 offen nt
  s_add_u32 s58, s58, 4096
  v_readlane_b32 s65, v10, 22
  v_perm_b32 v18, s64, s64, v6
  v_perm_b32 v19, s64, s64, v7
  v_perm_b32 v20, s64, s64, v8
  v_perm_b32 v21, s64, s64, v9
  v_mfma_f32_16x16x32_bf16 v[30:33], v[22:25], v[84:87], v[30:33]
  v_readlane_b32 s64, v10, 14
  v_perm_b32 v22, s65, s65, v6
  v_perm_b32 v23, s65, s65, v7
  v_perm_b32 v24, s65, s65, v8
  v_perm_b32 v25, s65, s65, v9
  v_mfma_f32_16x16x32_bf16 v[26:29], v[18:21], v[88:91], v[26:29]
  v_readlane_b32 s65, v10, 30
  v_perm_b32 v18, s64, s64, v6
  v_perm_b32 v19, s64, s64, v7
  v_perm_b32 v20, s64, s64, v8
  v_perm_b32 v21, s64, s64, v9
  v_mfma_f32_16x16x32_bf16 v[30:33], v[22:25], v[92:95], v[30:33]
  v_readlane_b32 s64, v10, 1
  v_perm_b32 v22, s65, s65, v6
  v_perm_b32 v23, s65, s65, v7
  v_perm_b32 v24, s65, s65, v8
  v_perm_b32 v25, s65, s65, v9
  s_waitcnt vmcnt(17)
  v_mfma_f32_16x16x32_bf16 v[26:29], v[18:21], v[96:99], v[26:29]
  v_readlane_b32 s65, v10, 17
  v_perm_b32 v18, s64, s64, v6
  v_perm_b32 v19, s64, s64, v7
  v_perm_b32 v20, s64, s64, v8
  v_perm_b32 v21, s64, s64, v9
  s_waitcnt vmcnt(16)
  v_mfma_f32_16x16x32_bf16 v[30:33], v[22:25], v[100:103], v[30:33]
  v_readlane_b32 s64, v10, 9
  v_perm_b32 v22, s65, s65, v6
  v_perm_b32 v23, s65, s65, v7
  v_perm_b32 v24, s65, s65, v8
  v_perm_b32 v25, s65, s65, v9
  s_waitcnt vmcnt(15)
  v_mfma_f32_16x16x32_bf16 v[26:29], v[18:21], v[104:107], v[26:29]
  v_readlane_b32 s65, v10, 25
  v_perm_b32 v18, s64, s64, v6
  v_perm_b32 v19, s64, s64, v7
  v_perm_b32 v20, s64, s64, v8
  v_perm_b32 v21, s64, s64, v9
  s_waitcnt vmcnt(14)
  v_mfma_f32_16x16x32_bf16 v[30:33], v[22:25], v[108:111], v[30:33]
  ds_add_u32 v35, v1 offset:4672
  v_readlane_b32 s64, v10, 5
  v_perm_b32 v22, s65, s65, v6
  v_perm_b32 v23, s65, s65, v7
  v_perm_b32 v24, s65, s65, v8
  v_perm_b32 v25, s65, s65, v9
  s_waitcnt vmcnt(13)
  v_mfma_f32_16x16x32_bf16 v[26:29], v[18:21], v[112:115], v[26:29]
  v_readlane_b32 s65, v10, 21
  v_perm_b32 v18, s64, s64, v6
  v_perm_b32 v19, s64, s64, v7
  v_perm_b32 v20, s64, s64, v8
  v_perm_b32 v21, s64, s64, v9
  s_waitcnt vmcnt(12)
  v_mfma_f32_16x16x32_bf16 v[30:33], v[22:25], v[116:119], v[30:33]
  v_readlane_b32 s64, v10, 13
  v_perm_b32 v22, s65, s65, v6
  v_perm_b32 v23, s65, s65, v7
  v_perm_b32 v24, s65, s65, v8
  v_perm_b32 v25, s65, s65, v9
  s_waitcnt vmcnt(11)
  v_mfma_f32_16x16x32_bf16 v[26:29], v[18:21], v[120:123], v[26:29]
  v_readlane_b32 s65, v10, 29
  v_perm_b32 v18, s64, s64, v6
  v_perm_b32 v19, s64, s64, v7
  v_perm_b32 v20, s64, s64, v8
  v_perm_b32 v21, s64, s64, v9
  s_waitcnt vmcnt(10)
  v_mfma_f32_16x16x32_bf16 v[30:33], v[22:25], v[124:127], v[30:33]
  v_readlane_b32 s64, v10, 3
  v_perm_b32 v22, s65, s65, v6
  v_perm_b32 v23, s65, s65, v7
  v_perm_b32 v24, s65, s65, v8
  v_perm_b32 v25, s65, s65, v9
  s_waitcnt vmcnt(9)
  v_mfma_f32_16x16x32_bf16 v[26:29], v[18:21], v[128:131], v[26:29]
  v_readlane_b32 s65, v10, 19
  v_perm_b32 v18, s64, s64, v6
  v_perm_b32 v19, s64, s64, v7
  v_perm_b32 v20, s64, s64, v8
  v_perm_b32 v21, s64, s64, v9
  s_waitcnt vmcnt(8)
  v_mfma_f32_16x16x32_bf16 v[30:33], v[22:25], v[132:135], v[30:33]
  v_readlane_b32 s64, v10, 11
  v_perm_b32 v22, s65, s65, v6
  v_perm_b32 v23, s65, s65, v7
  v_perm_b32 v24, s65, s65, v8
  v_perm_b32 v25, s65, s65, v9
  s_waitcnt vmcnt(7)
  v_mfma_f32_16x16x32_bf16 v[26:29], v[18:21], v[136:139], v[26:29]
  v_readlane_b32 s65, v10, 27
  v_perm_b32 v18, s64, s64, v6
  v_perm_b32 v19, s64, s64, v7
  v_perm_b32 v20, s64, s64, v8
  v_perm_b32 v21, s64, s64, v9
  s_waitcnt vmcnt(6)
  v_mfma_f32_16x16x32_bf16 v[30:33], v[22:25], v[140:143], v[30:33]
  v_readlane_b32 s64, v10, 7
  v_perm_b32 v22, s65, s65, v6
  v_perm_b32 v23, s65, s65, v7
  v_perm_b32 v24, s65, s65, v8
  v_perm_b32 v25, s65, s65, v9
  s_waitcnt vmcnt(5)
  v_mfma_f32_16x16x32_bf16 v[26:29], v[18:21], v[144:147], v[26:29]
  ds_read_b32 v37, v35 offset:4640
  v_readlane_b32 s65, v10, 23
  v_perm_b32 v18, s64, s64, v6
  v_perm_b32 v19, s64, s64, v7
  v_perm_b32 v20, s64, s64, v8
  v_perm_b32 v21, s64, s64, v9
  s_waitcnt vmcnt(4)
  v_mfma_f32_16x16x32_bf16 v[30:33], v[22:25], v[148:151], v[30:33]
  v_readlane_b32 s64, v10, 15
  v_perm_b32 v22, s65, s65, v6
  v_perm_b32 v23, s65, s65, v7
  v_perm_b32 v24, s65, s65, v8
  v_perm_b32 v25, s65, s65, v9
  s_waitcnt vmcnt(3)
  v_mfma_f32_16x16x32_bf16 v[26:29], v[18:21], v[152:155], v[26:29]
  v_readlane_b32 s65, v10, 31
  v_perm_b32 v18, s64, s64, v6
  v_perm_b32 v19, s64, s64, v7
  v_perm_b32 v20, s64, s64, v8
  v_perm_b32 v21, s64, s64, v9
  s_waitcnt vmcnt(2)
  v_mfma_f32_16x16x32_bf16 v[30:33], v[22:25], v[156:159], v[30:33]
  v_readlane_b32 s64, v11, 0
  v_perm_b32 v22, s65, s65, v6
  v_perm_b32 v23, s65, s65, v7
  v_perm_b32 v24, s65, s65, v8
  v_perm_b32 v25, s65, s65, v9
  s_waitcnt vmcnt(1)
  v_mfma_f32_16x16x32_bf16 v[26:29], v[18:21], v[160:163], v[26:29]
  v_readlane_b32 s65, v11, 16
  v_perm_b32 v18, s64, s64, v6
  v_perm_b32 v19, s64, s64, v7
  v_perm_b32 v20, s64, s64, v8
  v_perm_b32 v21, s64, s64, v9
  s_waitcnt vmcnt(0)
  v_mfma_f32_16x16x32_bf16 v[30:33], v[22:25], v[164:167], v[30:33]
  s_nop 7
L_vdone:
  s_waitcnt lgkmcnt(0)
  v_readfirstlane_b32 s59, v37
  v_add_f32 v26, v26, v30
  v_add_f32 v27, v27, v31
  v_add_f32 v28, v28, v32
  v_add_f32 v29, v29, v33
  s_cmp_eq_u32 s59, -1
  s_cbranch_scc1 L_coefwait
L_coefok:
  v_mul_f32 v26, v37, v26
  v_mul_f32 v27, v37, v27
  v_mul_f32 v28, v37, v28
  v_mul_f32 v29, v37, v29
  ds_write_b128 v38, v[26:29] offset:512
  s_mov_b64 exec, 1
  ds_add_rtn_u32 v36, v34, v36 offset:4656
  s_mov_b64 exec, -1
  ds_read_b128 v[168:171], v1 offset:512
  ds_read_b128 v[172:175], v1 offset:1536
  ds_read_b128 v[176:179], v1 offset:2560
  ds_read_b128 v[180:183], v1 offset:3584
  s_waitcnt lgkmcnt(4)
  v_readfirstlane_b32 s59, v36
  s_cmp_lg_u32 s59, 3
  s_nop 2
  s_cbranch_scc1 L_sdone
  s_waitcnt lgkmcnt(2)
  v_add_f32 v168, v168, v172
  v_add_f32 v169, v169, v173
  v_add_f32 v170, v170, v174
  v_add_f32 v171, v171, v175
  s_waitcnt lgkmcnt(0)
  v_add_f32 v176, v176, v180
  v_add_f32 v177, v177, v181
  v_add_f32 v178, v178, v182
  v_add_f32 v179, v179, v183
  v_add_f32 v168, v168, v176
  v_add_f32 v169, v169, v177
  v_add_f32 v170, v170, v178
  v_add_f32 v171, v171, v179
  v_cvt_pk_bf16_f32 v168, v168, v169
  v_cvt_pk_bf16_f32 v169, v170, v171
  v_min_u32 v168, -2, v168
  v_min_u32 v169, -2, v169
  buffer_store_dwordx2 v[168:169], v39, s[48:51], 0 offen sc1
  s_nop 0
L_sdone:
  s_endpgm
L_coefwait:
  s_mov_b32 s70, 0
L_coefloop:
  ds_read_b32 v37, v35 offset:4640
  s_add_u32 s70, s70, 1
  s_cmp_gt_u32 s70, 160000
  s_cbranch_scc1 L_coefok
  s_waitcnt lgkmcnt(0)
  v_readfirstlane_b32 s59, v37
  s_cmp_eq_u32 s59, -1
  s_nop 2
  s_cbranch_scc1 L_coefloop
  s_branch L_coefok
L_helper:
  s_mov_b32 s62, 0x05040100
  s_mov_b32 s63, 0x07060302
  v_and_b32 v2, 15, v0
  v_lshrrev_b32 v3, 4, v0
  s_cmp_eq_u32 s3, 5
  s_cbranch_scc1 L_w5
  s_cmp_gt_u32 s3, 5
  s_cbranch_scc1 L_w7
  s_and_b32 s34, s2, 7
  s_lshr_b32 s37, s2, 3
  s_lshr_b32 s35, s2, 4
  s_and_b32 s36, s37, 1
  s_sub_u32 s56, s2, 16
  s_and_b32 s57, s56, 1
  s_lshr_b32 s56, s56, 1
  s_sub_u32 s58, s56, 64
  s_lshr_b32 s59, s58, 1
  s_movk_i32 s64, 3584
  s_movk_i32 s66, 256
  s_cmp_lt_u32 s56, 64
  s_cselect_b32 s64, 8192, s64
  s_cselect_b32 s66, 32768, s66
  s_cselect_b32 s59, s56, s59
  s_lshl_b32 s59, s59, 7
  s_mul_i32 s65, s64, 25
  s_mul_i32 s60, s64, 224
  s_mul_i32 s60, s60, s57
  s_add_u32 s59, s59, s60
  s_mul_i32 s67, s64, 223
  s_add_u32 s67, s67, 128
  s_lshl_b32 s60, s64, 3
  v_mul_u32_u24 v1, s60, v3
  v_lshlrev_b32 v9, 3, v2
  v_add_u32 v1, v1, v9
  v_lshrrev_b32 v9, 2, v2
  v_lshlrev_b32 v9, 1, v9
  v_and_b32 v10, 1, v2
  v_add_u32 v10, v10, v9
  v_mul_u32_u24 v10, 896, v10
  v_lshlrev_b32 v9, 4, v3
  v_add_u32 v10, v10, v9
  s_mul_i32 s60, s57, 448
  s_lshr_b32 s68, s56, 2
  s_lshl_b32 s68, s68, 11
  s_and_b32 s69, s56, 3
  s_lshl_b32 s69, s69, 8
  s_add_u32 s68, s68, s69
  s_lshl_b32 s69, s57, 10
  s_add_u32 s68, s68, s69
  s_add_u32 s68, s68, 524288
  s_lshl_b32 s70, s58, 12
  s_lshl_b32 s69, s57, 11
  s_add_u32 s70, s70, s69
  s_add_u32 s70, s70, 1572864
  s_cmp_lt_u32 s56, 64
  s_cselect_b32 s68, s68, s70
  s_mov_b32 s61, 0
  s_waitcnt lgkmcnt(0)
  s_add_u32 s32, s32, 0x3fc00000
  s_addc_u32 s33, s33, 0
  s_load_dword s4, s[32:33], 0
  s_cmp_lt_u32 s2, 16
  s_cbranch_scc1 L_nopiece
  s_bitcmp1_b32 s58, 0
  s_cselect_b32 s40, s22, s20
  s_cselect_b32 s41, s23, s21
  s_cmp_lt_u32 s56, 64
  s_cselect_b32 s40, s14, s40
  s_cselect_b32 s41, s15, s41
  s_add_u32 s40, s40, s59
  s_addc_u32 s41, s41, 0
  s_mov_b32 s42, s67
  s_mov_b32 s43, 0x20000
  s_mov_b32 s44, s8
  s_mov_b32 s45, s9
  s_mov_b32 s46, 7168
  s_mov_b32 s47, 0x20000
  buffer_load_dwordx4 v[152:155], v10, s[44:47], s60 offen
  buffer_load_dwordx2 v[40:41], v1, s[40:43], s61 offen nt
  s_add_u32 s61, s61, s64
  buffer_load_dwordx2 v[42:43], v1, s[40:43], s61 offen nt
  s_add_u32 s61, s61, s64
  buffer_load_dwordx2 v[44:45], v1, s[40:43], s61 offen nt
  s_add_u32 s61, s61, s64
  buffer_load_dwordx2 v[46:47], v1, s[40:43], s61 offen nt
  s_add_u32 s61, s61, s64
  buffer_load_dwordx2 v[48:49], v1, s[40:43], s61 offen nt
  s_add_u32 s61, s61, s64
  buffer_load_dwordx2 v[50:51], v1, s[40:43], s61 offen nt
  s_add_u32 s61, s61, s64
  buffer_load_dwordx2 v[52:53], v1, s[40:43], s61 offen nt
  s_add_u32 s61, s61, s64
  buffer_load_dwordx2 v[54:55], v1, s[40:43], s61 offen nt
  s_add_u32 s61, s61, s65
  buffer_load_dwordx4 v[156:159], v10, s[44:47], s60 offen offset:64
  buffer_load_dwordx2 v[56:57], v1, s[40:43], s61 offen nt
  s_add_u32 s61, s61, s64
  buffer_load_dwordx2 v[58:59], v1, s[40:43], s61 offen nt
  s_add_u32 s61, s61, s64
  buffer_load_dwordx2 v[60:61], v1, s[40:43], s61 offen nt
  s_add_u32 s61, s61, s64
  buffer_load_dwordx2 v[62:63], v1, s[40:43], s61 offen nt
  s_add_u32 s61, s61, s64
  buffer_load_dwordx2 v[64:65], v1, s[40:43], s61 offen nt
  s_add_u32 s61, s61, s64
  buffer_load_dwordx2 v[66:67], v1, s[40:43], s61 offen nt
  s_add_u32 s61, s61, s64
  buffer_load_dwordx2 v[68:69], v1, s[40:43], s61 offen nt
  s_add_u32 s61, s61, s64
  buffer_load_dwordx2 v[70:71], v1, s[40:43], s61 offen nt
  s_add_u32 s61, s61, s65
  buffer_load_dwordx4 v[160:163], v10, s[44:47], s60 offen offset:128
  buffer_load_dwordx2 v[72:73], v1, s[40:43], s61 offen nt
  s_add_u32 s61, s61, s64
  buffer_load_dwordx2 v[74:75], v1, s[40:43], s61 offen nt
  s_add_u32 s61, s61, s64
  buffer_load_dwordx2 v[76:77], v1, s[40:43], s61 offen nt
  s_add_u32 s61, s61, s64
  buffer_load_dwordx2 v[78:79], v1, s[40:43], s61 offen nt
  s_add_u32 s61, s61, s64
  buffer_load_dwordx2 v[80:81], v1, s[40:43], s61 offen nt
  s_add_u32 s61, s61, s64
  buffer_load_dwordx2 v[82:83], v1, s[40:43], s61 offen nt
  s_add_u32 s61, s61, s64
  buffer_load_dwordx2 v[84:85], v1, s[40:43], s61 offen nt
  s_add_u32 s61, s61, s64
  buffer_load_dwordx2 v[86:87], v1, s[40:43], s61 offen nt
  s_add_u32 s61, s61, s65
  buffer_load_dwordx4 v[164:167], v10, s[44:47], s60 offen offset:192
  buffer_load_dwordx2 v[88:89], v1, s[40:43], s61 offen nt
  s_add_u32 s61, s61, s64
  buffer_load_dwordx2 v[90:91], v1, s[40:43], s61 offen nt
  s_add_u32 s61, s61, s64
  buffer_load_dwordx2 v[92:93], v1, s[40:43], s61 offen nt
  s_add_u32 s61, s61, s64
  buffer_load_dwordx2 v[94:95], v1, s[40:43], s61 offen nt
  s_add_u32 s61, s61, s64
  buffer_load_dwordx2 v[96:97], v1, s[40:43], s61 offen nt
  s_add_u32 s61, s61, s64
  buffer_load_dwordx2 v[98:99], v1, s[40:43], s61 offen nt
  s_add_u32 s61, s61, s64
  buffer_load_dwordx2 v[100:101], v1, s[40:43], s61 offen nt
  s_add_u32 s61, s61, s64
  buffer_load_dwordx2 v[102:103], v1, s[40:43], s61 offen nt
  s_add_u32 s61, s61, s65
  buffer_load_dwordx4 v[168:171], v10, s[44:47], s60 offen offset:256
  buffer_load_dwordx2 v[104:105], v1, s[40:43], s61 offen nt
  s_add_u32 s61, s61, s64
  buffer_load_dwordx2 v[106:107], v1, s[40:43], s61 offen nt
  s_add_u32 s61, s61, s64
  buffer_load_dwordx2 v[108:109], v1, s[40:43], s61 offen nt
  s_add_u32 s61, s61, s64
  buffer_load_dwordx2 v[110:111], v1, s[40:43], s61 offen nt
  s_add_u32 s61, s61, s64
  buffer_load_dwordx2 v[112:113], v1, s[40:43], s61 offen nt
  s_add_u32 s61, s61, s64
  buffer_load_dwordx2 v[114:115], v1, s[40:43], s61 offen nt
  s_add_u32 s61, s61, s64
  buffer_load_dwordx2 v[116:117], v1, s[40:43], s61 offen nt
  s_add_u32 s61, s61, s64
  buffer_load_dwordx2 v[118:119], v1, s[40:43], s61 offen nt
  s_add_u32 s61, s61, s65
  buffer_load_dwordx4 v[172:175], v10, s[44:47], s60 offen offset:320
  buffer_load_dwordx2 v[120:121], v1, s[40:43], s61 offen nt
  s_add_u32 s61, s61, s64
  buffer_load_dwordx2 v[122:123], v1, s[40:43], s61 offen nt
  s_add_u32 s61, s61, s64
  buffer_load_dwordx2 v[124:125], v1, s[40:43], s61 offen nt
  s_add_u32 s61, s61, s64
  buffer_load_dwordx2 v[126:127], v1, s[40:43], s61 offen nt
  s_add_u32 s61, s61, s64
  buffer_load_dwordx2 v[128:129], v1, s[40:43], s61 offen nt
  s_add_u32 s61, s61, s64
  buffer_load_dwordx2 v[130:131], v1, s[40:43], s61 offen nt
  s_add_u32 s61, s61, s64
  buffer_load_dwordx2 v[132:133], v1, s[40:43], s61 offen nt
  s_add_u32 s61, s61, s64
  buffer_load_dwordx2 v[134:135], v1, s[40:43], s61 offen nt
  s_add_u32 s61, s61, s65
  buffer_load_dwordx4 v[176:179], v10, s[44:47], s60 offen offset:384
  buffer_load_dwordx2 v[136:137], v1, s[40:43], s61 offen nt
  s_add_u32 s61, s61, s64
  buffer_load_dwordx2 v[138:139], v1, s[40:43], s61 offen nt
  s_add_u32 s61, s61, s64
  buffer_load_dwordx2 v[140:141], v1, s[40:43], s61 offen nt
  s_add_u32 s61, s61, s64
  buffer_load_dwordx2 v[142:143], v1, s[40:43], s61 offen nt
  s_add_u32 s61, s61, s64
  buffer_load_dwordx2 v[144:145], v1, s[40:43], s61 offen nt
  s_add_u32 s61, s61, s64
  buffer_load_dwordx2 v[146:147], v1, s[40:43], s61 offen nt
  s_add_u32 s61, s61, s64
  buffer_load_dwordx2 v[148:149], v1, s[40:43], s61 offen nt
  s_add_u32 s61, s61, s64
  buffer_load_dwordx2 v[150:151], v1, s[40:43], s61 offen nt
  s_mul_i32 s67, s66, 7
  s_add_u32 s67, s67, 256
  s_add_u32 s48, s32, s68
  s_addc_u32 s49, s33, 0
  s_mov_b32 s50, s67
  s_mov_b32 s51, 0x20000
  s_lshl_b32 s60, s66, 1
  v_mul_u32_u24 v1, s60, v3
  v_lshlrev_b32 v9, 4, v2
  v_add_u32 v1, v1, v9
  s_waitcnt lgkmcnt(0)
  s_add_u32 s4, s4, 0x01010101
  s_mov_b32 s5, 0xff
  s_mov_b32 s6, 0x0c0c0400
  s_mov_b32 s7, 0x04000c0c
  v_mov_b32 v4, s4
  v_mov_b32 v11, 0x80
  v_lshrrev_b32 v5, 8, v4
  v_lshrrev_b32 v6, 16, v4
  v_lshrrev_b32 v7, 24, v4
  s_waitcnt vmcnt(54)
  v_perm_b32 v180, v42, v40, s62
  v_perm_b32 v181, v46, v44, s62
  v_perm_b32 v182, v50, v48, s62
  v_perm_b32 v183, v54, v52, s62
  v_perm_b32 v184, v42, v40, s63
  v_perm_b32 v185, v46, v44, s63
  v_perm_b32 v186, v50, v48, s63
  v_perm_b32 v187, v54, v52, s63
  v_perm_b32 v188, v43, v41, s62
  v_perm_b32 v189, v47, v45, s62
  v_perm_b32 v190, v51, v49, s62
  v_perm_b32 v191, v55, v53, s62
  v_perm_b32 v192, v43, v41, s63
  v_perm_b32 v193, v47, v45, s63
  v_perm_b32 v194, v51, v49, s63
  v_perm_b32 v195, v55, v53, s63
  v_mfma_f32_16x16x32_bf16 v[24:27], v[152:155], v[180:183], 0
  v_mfma_f32_16x16x32_bf16 v[28:31], v[152:155], v[184:187], 0
  v_mfma_f32_16x16x32_bf16 v[32:35], v[152:155], v[188:191], 0
  v_mfma_f32_16x16x32_bf16 v[36:39], v[152:155], v[192:195], 0
  s_waitcnt vmcnt(45)
  v_perm_b32 v196, v58, v56, s62
  v_perm_b32 v197, v62, v60, s62
  v_perm_b32 v198, v66, v64, s62
  v_perm_b32 v199, v70, v68, s62
  v_perm_b32 v200, v58, v56, s63
  v_perm_b32 v201, v62, v60, s63
  v_perm_b32 v202, v66, v64, s63
  v_perm_b32 v203, v70, v68, s63
  v_perm_b32 v204, v59, v57, s62
  v_perm_b32 v205, v63, v61, s62
  v_perm_b32 v206, v67, v65, s62
  v_perm_b32 v207, v71, v69, s62
  v_perm_b32 v208, v59, v57, s63
  v_perm_b32 v209, v63, v61, s63
  v_perm_b32 v210, v67, v65, s63
  v_perm_b32 v211, v71, v69, s63
  v_mfma_f32_16x16x32_bf16 v[24:27], v[156:159], v[196:199], v[24:27]
  v_mfma_f32_16x16x32_bf16 v[28:31], v[156:159], v[200:203], v[28:31]
  v_mfma_f32_16x16x32_bf16 v[32:35], v[156:159], v[204:207], v[32:35]
  v_mfma_f32_16x16x32_bf16 v[36:39], v[156:159], v[208:211], v[36:39]
  s_waitcnt vmcnt(36)
  v_perm_b32 v180, v74, v72, s62
  v_perm_b32 v181, v78, v76, s62
  v_perm_b32 v182, v82, v80, s62
  v_perm_b32 v183, v86, v84, s62
  v_perm_b32 v184, v74, v72, s63
  v_perm_b32 v185, v78, v76, s63
  v_perm_b32 v186, v82, v80, s63
  v_perm_b32 v187, v86, v84, s63
  v_perm_b32 v188, v75, v73, s62
  v_perm_b32 v189, v79, v77, s62
  v_perm_b32 v190, v83, v81, s62
  v_perm_b32 v191, v87, v85, s62
  v_perm_b32 v192, v75, v73, s63
  v_perm_b32 v193, v79, v77, s63
  v_perm_b32 v194, v83, v81, s63
  v_perm_b32 v195, v87, v85, s63
  v_mfma_f32_16x16x32_bf16 v[24:27], v[160:163], v[180:183], v[24:27]
  v_mfma_f32_16x16x32_bf16 v[28:31], v[160:163], v[184:187], v[28:31]
  v_mfma_f32_16x16x32_bf16 v[32:35], v[160:163], v[188:191], v[32:35]
  v_mfma_f32_16x16x32_bf16 v[36:39], v[160:163], v[192:195], v[36:39]
  s_waitcnt vmcnt(27)
  v_perm_b32 v196, v90, v88, s62
  v_perm_b32 v197, v94, v92, s62
  v_perm_b32 v198, v98, v96, s62
  v_perm_b32 v199, v102, v100, s62
  v_perm_b32 v200, v90, v88, s63
  v_perm_b32 v201, v94, v92, s63
  v_perm_b32 v202, v98, v96, s63
  v_perm_b32 v203, v102, v100, s63
  v_perm_b32 v204, v91, v89, s62
  v_perm_b32 v205, v95, v93, s62
  v_perm_b32 v206, v99, v97, s62
  v_perm_b32 v207, v103, v101, s62
  v_perm_b32 v208, v91, v89, s63
  v_perm_b32 v209, v95, v93, s63
  v_perm_b32 v210, v99, v97, s63
  v_perm_b32 v211, v103, v101, s63
  v_mfma_f32_16x16x32_bf16 v[24:27], v[164:167], v[196:199], v[24:27]
  v_mfma_f32_16x16x32_bf16 v[28:31], v[164:167], v[200:203], v[28:31]
  v_mfma_f32_16x16x32_bf16 v[32:35], v[164:167], v[204:207], v[32:35]
  v_mfma_f32_16x16x32_bf16 v[36:39], v[164:167], v[208:211], v[36:39]
  s_waitcnt vmcnt(18)
  v_perm_b32 v180, v106, v104, s62
  v_perm_b32 v181, v110, v108, s62
  v_perm_b32 v182, v114, v112, s62
  v_perm_b32 v183, v118, v116, s62
  v_perm_b32 v184, v106, v104, s63
  v_perm_b32 v185, v110, v108, s63
  v_perm_b32 v186, v114, v112, s63
  v_perm_b32 v187, v118, v116, s63
  v_perm_b32 v188, v107, v105, s62
  v_perm_b32 v189, v111, v109, s62
  v_perm_b32 v190, v115, v113, s62
  v_perm_b32 v191, v119, v117, s62
  v_perm_b32 v192, v107, v105, s63
  v_perm_b32 v193, v111, v109, s63
  v_perm_b32 v194, v115, v113, s63
  v_perm_b32 v195, v119, v117, s63
  v_mfma_f32_16x16x32_bf16 v[24:27], v[168:171], v[180:183], v[24:27]
  v_mfma_f32_16x16x32_bf16 v[28:31], v[168:171], v[184:187], v[28:31]
  v_mfma_f32_16x16x32_bf16 v[32:35], v[168:171], v[188:191], v[32:35]
  v_mfma_f32_16x16x32_bf16 v[36:39], v[168:171], v[192:195], v[36:39]
  s_waitcnt vmcnt(9)
  v_perm_b32 v196, v122, v120, s62
  v_perm_b32 v197, v126, v124, s62
  v_perm_b32 v198, v130, v128, s62
  v_perm_b32 v199, v134, v132, s62
  v_perm_b32 v200, v122, v120, s63
  v_perm_b32 v201, v126, v124, s63
  v_perm_b32 v202, v130, v128, s63
  v_perm_b32 v203, v134, v132, s63
  v_perm_b32 v204, v123, v121, s62
  v_perm_b32 v205, v127, v125, s62
  v_perm_b32 v206, v131, v129, s62
  v_perm_b32 v207, v135, v133, s62
  v_perm_b32 v208, v123, v121, s63
  v_perm_b32 v209, v127, v125, s63
  v_perm_b32 v210, v131, v129, s63
  v_perm_b32 v211, v135, v133, s63
  v_mfma_f32_16x16x32_bf16 v[24:27], v[172:175], v[196:199], v[24:27]
  v_mfma_f32_16x16x32_bf16 v[28:31], v[172:175], v[200:203], v[28:31]
  v_mfma_f32_16x16x32_bf16 v[32:35], v[172:175], v[204:207], v[32:35]
  v_mfma_f32_16x16x32_bf16 v[36:39], v[172:175], v[208:211], v[36:39]
  s_waitcnt vmcnt(0)
  v_perm_b32 v180, v138, v136, s62
  v_perm_b32 v181, v142, v140, s62
  v_perm_b32 v182, v146, v144, s62
  v_perm_b32 v183, v150, v148, s62
  v_perm_b32 v184, v138, v136, s63
  v_perm_b32 v185, v142, v140, s63
  v_perm_b32 v186, v146, v144, s63
  v_perm_b32 v187, v150, v148, s63
  v_perm_b32 v188, v139, v137, s62
  v_perm_b32 v189, v143, v141, s62
  v_perm_b32 v190, v147, v145, s62
  v_perm_b32 v191, v151, v149, s62
  v_perm_b32 v192, v139, v137, s63
  v_perm_b32 v193, v143, v141, s63
  v_perm_b32 v194, v147, v145, s63
  v_perm_b32 v195, v151, v149, s63
  v_mfma_f32_16x16x32_bf16 v[24:27], v[176:179], v[180:183], v[24:27]
  v_mfma_f32_16x16x32_bf16 v[28:31], v[176:179], v[184:187], v[28:31]
  v_mfma_f32_16x16x32_bf16 v[32:35], v[176:179], v[188:191], v[32:35]
  v_mfma_f32_16x16x32_bf16 v[36:39], v[176:179], v[192:195], v[36:39]
  s_nop 4
  v_bfi_b32 v40, s5, v4, v24
  v_bfi_b32 v41, s5, v5, v28
  v_bfi_b32 v42, s5, v6, v32
  v_bfi_b32 v43, s5, v7, v36
  buffer_store_dwordx4 v[40:43], v1, s[48:51], 0 offen sc1
  v_bfi_b32 v44, s5, v4, v25
  v_bfi_b32 v45, s5, v5, v29
  v_bfi_b32 v46, s5, v6, v33
  v_bfi_b32 v47, s5, v7, v37
  buffer_store_dwordx4 v[44:47], v1, s[48:51], s66 offen sc1
  s_cmp_eq_u32 s34, 7
  s_cbranch_scc1 L_w4_done
  s_branch L_w4b
L_nopiece:
  s_waitcnt lgkmcnt(0)
  s_add_u32 s4, s4, 0x01010101
  s_mov_b32 s5, 0xff
  s_mov_b32 s6, 0x0c0c0400
  s_mov_b32 s7, 0x04000c0c
  v_mov_b32 v4, s4
  v_mov_b32 v11, 0x80
  v_lshrrev_b32 v5, 8, v4
  v_lshrrev_b32 v6, 16, v4
  v_lshrrev_b32 v7, 24, v4
  s_cmp_eq_u32 s34, 7
  s_cbranch_scc1 L_w4_done
L_w4b:
  s_barrier
  s_mul_i32 s58, s37, 114688
  s_lshl_b32 s59, s34, 7
  s_add_u32 s58, s58, s59
  s_add_u32 s16, s16, s58
  s_addc_u32 s17, s17, 0
  s_mov_b32 s18, 0
  s_mov_b32 s19, 0x20000
  s_mul_i32 s58, s37, 57344
  s_add_u32 s58, s58, s59
  s_cmp_lt_u32 s37, 28
  s_cselect_b32 s58, s58, 0
  s_add_u32 s24, s24, s58
  s_addc_u32 s25, s25, 0
  s_mov_b32 s26, 0
  s_mov_b32 s27, 0x20000
  v_mul_u32_u24 v14, 7168, v3
  v_lshlrev_b32 v9, 3, v2
  v_add_u32 v14, v14, v9
  s_lshl_b32 s58, s37, 13
  s_add_u32 s58, s58, 1572864
  s_add_u32 s48, s32, s58
  s_addc_u32 s49, s33, 0
  s_mov_b32 s50, 8192
  s_mov_b32 s51, 0x20000
  v_lshlrev_b32 v10, 4, v0
  v_mov_b32 v16, 0
  v_mov_b32 v17, 0
  v_mov_b32 v18, 0
  v_mov_b32 v19, 0
  s_cmp_ge_u32 s37, 28
  s_cbranch_scc1 L_noffn
  s_mov_b64 s[64:65], -1
  s_mov_b64 s[66:67], -1
  s_mov_b64 s[68:69], -1
  s_mov_b64 s[70:71], -1
  s_mov_b64 s[72:73], -1
  s_mov_b64 s[74:75], -1
  s_mov_b64 s[76:77], -1
  s_mov_b64 s[78:79], -1
  s_mov_b32 s54, 0
  s_mov_b32 s59, 4096
  buffer_load_dwordx4 v[40:43], v10, s[48:51], 0 offen
  buffer_load_dwordx4 v[44:47], v10, s[48:51], 0 offen offset:1024
  buffer_load_dwordx4 v[48:51], v10, s[48:51], 0 offen offset:2048
  buffer_load_dwordx4 v[52:55], v10, s[48:51], 0 offen offset:3072
  buffer_load_dwordx4 v[56:59], v10, s[48:51], s59 offen
  buffer_load_dwordx4 v[60:63], v10, s[48:51], s59 offen offset:1024
  buffer_load_dwordx4 v[64:67], v10, s[48:51], s59 offen offset:2048
  buffer_load_dwordx4 v[68:71], v10, s[48:51], s59 offen offset:3072
  s_branch L_gupoll_w
L_gupoll:
  s_mov_b64 exec, s[64:65]
  buffer_load_dwordx4 v[40:43], v10, s[48:51], 0 offen sc1
  s_mov_b64 exec, s[66:67]
  buffer_load_dwordx4 v[44:47], v10, s[48:51], 0 offen offset:1024 sc1
  s_mov_b64 exec, s[68:69]
  buffer_load_dwordx4 v[48:51], v10, s[48:51], 0 offen offset:2048 sc1
  s_mov_b64 exec, s[70:71]
  buffer_load_dwordx4 v[52:55], v10, s[48:51], 0 offen offset:3072 sc1
  s_mov_b64 exec, s[72:73]
  buffer_load_dwordx4 v[56:59], v10, s[48:51], s59 offen sc1
  s_mov_b64 exec, s[74:75]
  buffer_load_dwordx4 v[60:63], v10, s[48:51], s59 offen offset:1024 sc1
  s_mov_b64 exec, s[76:77]
  buffer_load_dwordx4 v[64:67], v10, s[48:51], s59 offen offset:2048 sc1
  s_mov_b64 exec, s[78:79]
  buffer_load_dwordx4 v[68:71], v10, s[48:51], s59 offen offset:3072 sc1
L_gupoll_w:
  s_add_u32 s54, s54, 1
  s_waitcnt vmcnt(0)
  s_mov_b64 exec, s[64:65]
  v_perm_b32 v8, v41, v40, s6
  v_perm_b32 v9, v43, v42, s7
  v_or_b32 v8, v8, v9
  v_cmp_ne_u32_e64 s[64:65], v8, v4
  s_wqm_b64 s[64:65], s[64:65]
  s_mov_b64 exec, s[66:67]
  v_perm_b32 v8, v45, v44, s6
  v_perm_b32 v9, v47, v46, s7
  v_or_b32 v8, v8, v9
  v_cmp_ne_u32_e64 s[66:67], v8, v4
  s_wqm_b64 s[66:67], s[66:67]
  s_mov_b64 exec, s[68:69]
  v_perm_b32 v8, v49, v48, s6
  v_perm_b32 v9, v51, v50, s7
  v_or_b32 v8, v8, v9
  v_cmp_ne_u32_e64 s[68:69], v8, v4
  s_wqm_b64 s[68:69], s[68:69]
  s_mov_b64 exec, s[70:71]
  v_perm_b32 v8, v53, v52, s6
  v_perm_b32 v9, v55, v54, s7
  v_or_b32 v8, v8, v9
  v_cmp_ne_u32_e64 s[70:71], v8, v4
  s_wqm_b64 s[70:71], s[70:71]
  s_mov_b64 exec, s[72:73]
  v_perm_b32 v8, v57, v56, s6
  v_perm_b32 v9, v59, v58, s7
  v_or_b32 v8, v8, v9
  v_cmp_ne_u32_e64 s[72:73], v8, v4
  s_wqm_b64 s[72:73], s[72:73]
  s_mov_b64 exec, s[74:75]
  v_perm_b32 v8, v61, v60, s6
  v_perm_b32 v9, v63, v62, s7
  v_or_b32 v8, v8, v9
  v_cmp_ne_u32_e64 s[74:75], v8, v4
  s_wqm_b64 s[74:75], s[74:75]
  s_mov_b64 exec, s[76:77]
  v_perm_b32 v8, v65, v64, s6
  v_perm_b32 v9, v67, v66, s7
  v_or_b32 v8, v8, v9
  v_cmp_ne_u32_e64 s[76:77], v8, v4
  s_wqm_b64 s[76:77], s[76:77]
  s_mov_b64 exec, s[78:79]
  v_perm_b32 v8, v69, v68, s6
  v_perm_b32 v9, v71, v70, s7
  v_or_b32 v8, v8, v9
  v_cmp_ne_u32_e64 s[78:79], v8, v4
  s_wqm_b64 s[78:79], s[78:79]
  s_mov_b64 exec, -1
  s_or_b64 s[80:81], s[64:65], s[66:67]
  s_or_b64 s[80:81], s[80:81], s[68:69]
  s_or_b64 s[80:81], s[80:81], s[70:71]
  s_or_b64 s[80:81], s[80:81], s[72:73]
  s_or_b64 s[80:81], s[80:81], s[74:75]
  s_or_b64 s[80:81], s[80:81], s[76:77]
  s_or_b64 s[80:81], s[80:81], s[78:79]
  s_cmp_gt_u32 s54, 20000
  s_cselect_b64 s[80:81], 0, s[80:81]
  s_cmp_lg_u64 s[80:81], 0
  s_cbranch_scc1 L_gupoll
  v_bfi_b32 v40, s5, v11, v40
  v_bfi_b32 v41, s5, v11, v41
  v_bfi_b32 v42, s5, v11, v42
  v_bfi_b32 v43, s5, v11, v43
  v_bfi_b32 v44, s5, v11, v44
  v_bfi_b32 v45, s5, v11, v45
  v_bfi_b32 v46, s5, v11, v46
  v_bfi_b32 v47, s5, v11, v47
  v_bfi_b32 v48, s5, v11, v48
  v_bfi_b32 v49, s5, v11, v49
  v_bfi_b32 v50, s5, v11, v50
  v_bfi_b32 v51, s5, v11, v51
  v_bfi_b32 v52, s5, v11, v52
  v_bfi_b32 v53, s5, v11, v53
  v_bfi_b32 v54, s5, v11, v54
  v_bfi_b32 v55, s5, v11, v55
  v_bfi_b32 v56, s5, v11, v56
  v_bfi_b32 v57, s5, v11, v57
  v_bfi_b32 v58, s5, v11, v58
  v_bfi_b32 v59, s5, v11, v59
  v_bfi_b32 v60, s5, v11, v60
  v_bfi_b32 v61, s5, v11, v61
  v_bfi_b32 v62, s5, v11, v62
  v_bfi_b32 v63, s5, v11, v63
  v_bfi_b32 v64, s5, v11, v64
  v_bfi_b32 v65, s5, v11, v65
  v_bfi_b32 v66, s5, v11, v66
  v_bfi_b32 v67, s5, v11, v67
  v_bfi_b32 v68, s5, v11, v68
  v_bfi_b32 v69, s5, v11, v69
  v_bfi_b32 v70, s5, v11, v70
  v_bfi_b32 v71, s5, v11, v71
  v_add_f32 v16, v40, v48
  v_add_f32 v17, v41, v49
  v_add_f32 v18, v42, v50
  v_add_f32 v19, v43, v51
  v_add_f32 v20, v44, v52
  v_add_f32 v21, v45, v53
  v_add_f32 v22, v46, v54
  v_add_f32 v23, v47, v55
  v_add_f32 v24, v56, v64
  v_add_f32 v25, v57, v65
  v_add_f32 v26, v58, v66
  v_add_f32 v27, v59, v67
  v_add_f32 v28, v60, v68
  v_add_f32 v29, v61, v69
  v_add_f32 v30, v62, v70
  v_add_f32 v31, v63, v71
  v_cvt_pk_bf16_f32 v32, v16, v17
  v_cvt_pk_bf16_f32 v33, v18, v19
  v_cvt_pk_bf16_f32 v34, v20, v21
  v_cvt_pk_bf16_f32 v35, v22, v23
  v_cvt_pk_bf16_f32 v36, v24, v25
  v_cvt_pk_bf16_f32 v37, v26, v27
  v_cvt_pk_bf16_f32 v38, v28, v29
  v_cvt_pk_bf16_f32 v39, v30, v31
  v_lshlrev_b32 v16, 16, v32
  v_and_b32 v17, 0xffff0000, v32
  v_lshlrev_b32 v18, 16, v33
  v_and_b32 v19, 0xffff0000, v33
  v_lshlrev_b32 v20, 16, v34
  v_and_b32 v21, 0xffff0000, v34
  v_lshlrev_b32 v22, 16, v35
  v_and_b32 v23, 0xffff0000, v35
  v_lshlrev_b32 v24, 16, v36
  v_and_b32 v25, 0xffff0000, v36
  v_lshlrev_b32 v26, 16, v37
  v_and_b32 v27, 0xffff0000, v37
  v_lshlrev_b32 v28, 16, v38
  v_and_b32 v29, 0xffff0000, v38
  v_lshlrev_b32 v30, 16, v39
  v_and_b32 v31, 0xffff0000, v39
  v_mul_f32 v32, 0xbfb8aa3b, v16
  v_mul_f32 v33, 0xbfb8aa3b, v17
  v_mul_f32 v34, 0xbfb8aa3b, v18
  v_mul_f32 v35, 0xbfb8aa3b, v19
  v_mul_f32 v36, 0xbfb8aa3b, v20
  v_mul_f32 v37, 0xbfb8aa3b, v21
  v_mul_f32 v38, 0xbfb8aa3b, v22
  v_mul_f32 v39, 0xbfb8aa3b, v23
  v_exp_f32 v32, v32
  v_exp_f32 v33, v33
  v_exp_f32 v34, v34
  v_exp_f32 v35, v35
  v_exp_f32 v36, v36
  v_exp_f32 v37, v37
  v_exp_f32 v38, v38
  v_exp_f32 v39, v39
  v_add_f32 v32, 1.0, v32
  v_add_f32 v33, 1.0, v33
  v_add_f32 v34, 1.0, v34
  v_add_f32 v35, 1.0, v35
  v_add_f32 v36, 1.0, v36
  v_add_f32 v37, 1.0, v37
  v_add_f32 v38, 1.0, v38
  v_add_f32 v39, 1.0, v39
  v_rcp_f32 v32, v32
  v_rcp_f32 v33, v33
  v_rcp_f32 v34, v34
  v_rcp_f32 v35, v35
  v_rcp_f32 v36, v36
  v_rcp_f32 v37, v37
  v_rcp_f32 v38, v38
  v_rcp_f32 v39, v39
  v_mul_f32 v16, v16, v32
  v_mul_f32 v17, v17, v33
  v_mul_f32 v18, v18, v34
  v_mul_f32 v19, v19, v35
  v_mul_f32 v20, v20, v36
  v_mul_f32 v21, v21, v37
  v_mul_f32 v22, v22, v38
  v_mul_f32 v23, v23, v39
  v_cvt_pk_bf16_f32 v32, v16, v17
  v_cvt_pk_bf16_f32 v33, v18, v19
  v_cvt_pk_bf16_f32 v34, v20, v21
  v_cvt_pk_bf16_f32 v35, v22, v23
  v_lshlrev_b32 v16, 16, v32
  v_and_b32 v17, 0xffff0000, v32
  v_lshlrev_b32 v18, 16, v33
  v_and_b32 v19, 0xffff0000, v33
  v_lshlrev_b32 v20, 16, v34
  v_and_b32 v21, 0xffff0000, v34
  v_lshlrev_b32 v22, 16, v35
  v_and_b32 v23, 0xffff0000, v35
  v_mul_f32 v16, v16, v24
  v_mul_f32 v17, v17, v25
  v_mul_f32 v18, v18, v26
  v_mul_f32 v19, v19, v27
  v_mul_f32 v20, v20, v28
  v_mul_f32 v21, v21, v29
  v_mul_f32 v22, v22, v30
  v_mul_f32 v23, v23, v31
  v_cvt_pk_bf16_f32 v16, v16, v17
  v_cvt_pk_bf16_f32 v17, v18, v19
  v_cvt_pk_bf16_f32 v18, v20, v21
  v_cvt_pk_bf16_f32 v19, v22, v23
  v_mul_u32_u24 v9, 144, v3
  v_lshlrev_b32 v8, 3, v2
  v_add_u32 v9, v9, v8
  ds_write_b64 v9, v[16:17] offset:4736
  ds_write_b64 v9, v[18:19] offset:5312
  v_lshrrev_b32 v8, 1, v2
  v_mul_u32_u24 v9, 144, v8
  v_and_b32 v8, 1, v2
  v_lshlrev_b32 v8, 6, v8
  v_add_u32 v9, v9, v8
  v_lshlrev_b32 v8, 4, v3
  v_add_u32 v9, v9, v8
  ds_read_b128 v[16:19], v9 offset:4736
  s_waitcnt lgkmcnt(0)
L_noffn:
  s_lshl_b32 s58, s35, 13
  s_lshl_b32 s59, s36, 8
  s_add_u32 s58, s58, s59
  s_add_u32 s58, s58, 131072
  s_add_u32 s44, s32, s58
  s_addc_u32 s45, s33, 0
  s_mov_b32 s46, 7936
  s_mov_b32 s47, 0x20000
  s_mul_i32 s58, s37, 1792
  s_lshl_b32 s59, s34, 8
  s_add_u32 s58, s58, s59
  s_add_u32 s58, s58, 1048576
  s_add_u32 s48, s32, s58
  s_addc_u32 s49, s33, 0
  s_mov_b32 s50, 0
  s_mov_b32 s51, 0x20000
  v_mul_u32_u24 v9, 114688, v3
  v_lshlrev_b32 v8, 4, v2
  v_add_u32 v9, v9, v8
  v_lshlrev_b32 v1, 9, v2
  v_lshlrev_b32 v8, 4, v3
  v_add_u32 v1, v1, v8
  v_lshlrev_b32 v10, 3, v3
  s_mov_b32 s59, 57344
  s_mov_b32 s78, 0x100000
  s_mov_b32 s79, 1105920
  s_mov_b32 s61, 0
  s_mov_b64 s[64:65], 0
  s_mov_b64 s[66:67], 0
  s_mov_b64 s[68:69], 0
  s_mov_b64 s[70:71], 0
L_proj:
  s_mov_b32 s57, 0
  buffer_load_dwordx2 v[168:169], v14, s[24:27], s57 offen nt
  buffer_load_dwordx2 v[40:41], v14, s[16:19], s57 offen nt
  buffer_load_dwordx2 v[170:171], v14, s[24:27], s57 offen offset:896 nt
  buffer_load_dwordx2 v[42:43], v14, s[16:19], s57 offen offset:896 nt
  buffer_load_dwordx2 v[172:173], v14, s[24:27], s57 offen offset:1792 nt
  buffer_load_dwordx2 v[44:45], v14, s[16:19], s57 offen offset:1792 nt
  buffer_load_dwordx2 v[174:175], v14, s[24:27], s57 offen offset:2688 nt
  buffer_load_dwordx2 v[46:47], v14, s[16:19], s57 offen offset:2688 nt
  s_add_u32 s57, s57, 3584
  buffer_load_dwordx2 v[176:177], v14, s[24:27], s57 offen nt
  buffer_load_dwordx2 v[48:49], v14, s[16:19], s57 offen nt
  buffer_load_dwordx2 v[178:179], v14, s[24:27], s57 offen offset:896 nt
  buffer_load_dwordx2 v[50:51], v14, s[16:19], s57 offen offset:896 nt
  buffer_load_dwordx2 v[180:181], v14, s[24:27], s57 offen offset:1792 nt
  buffer_load_dwordx2 v[52:53], v14, s[16:19], s57 offen offset:1792 nt
  buffer_load_dwordx2 v[182:183], v14, s[24:27], s57 offen offset:2688 nt
  buffer_load_dwordx2 v[54:55], v14, s[16:19], s57 offen offset:2688 nt
  s_add_u32 s57, s57, 25088
  buffer_load_dwordx2 v[184:185], v14, s[24:27], s57 offen nt
  buffer_load_dwordx2 v[56:57], v14, s[16:19], s57 offen nt
  buffer_load_dwordx2 v[186:187], v14, s[24:27], s57 offen offset:896 nt
  buffer_load_dwordx2 v[58:59], v14, s[16:19], s57 offen offset:896 nt
  buffer_load_dwordx2 v[188:189], v14, s[24:27], s57 offen offset:1792 nt
  buffer_load_dwordx2 v[60:61], v14, s[16:19], s57 offen offset:1792 nt
  buffer_load_dwordx2 v[190:191], v14, s[24:27], s57 offen offset:2688 nt
  buffer_load_dwordx2 v[62:63], v14, s[16:19], s57 offen offset:2688 nt
  s_add_u32 s57, s57, 3584
  buffer_load_dwordx2 v[192:193], v14, s[24:27], s57 offen nt
  buffer_load_dwordx2 v[64:65], v14, s[16:19], s57 offen nt
  buffer_load_dwordx2 v[194:195], v14, s[24:27], s57 offen offset:896 nt
  buffer_load_dwordx2 v[66:67], v14, s[16:19], s57 offen offset:896 nt
  buffer_load_dwordx2 v[196:197], v14, s[24:27], s57 offen offset:1792 nt
  buffer_load_dwordx2 v[68:69], v14, s[16:19], s57 offen offset:1792 nt
  buffer_load_dwordx2 v[198:199], v14, s[24:27], s57 offen offset:2688 nt
  buffer_load_dwordx2 v[70:71], v14, s[16:19], s57 offen offset:2688 nt
  s_add_u32 s57, s57, 25088
  buffer_load_dwordx2 v[72:73], v14, s[16:19], s57 offen nt
  buffer_load_dwordx2 v[74:75], v14, s[16:19], s57 offen offset:896 nt
  buffer_load_dwordx2 v[76:77], v14, s[16:19], s57 offen offset:1792 nt
  buffer_load_dwordx2 v[78:79], v14, s[16:19], s57 offen offset:2688 nt
  s_add_u32 s57, s57, 3584
  buffer_load_dwordx2 v[80:81], v14, s[16:19], s57 offen nt
  buffer_load_dwordx2 v[82:83], v14, s[16:19], s57 offen offset:896 nt
  buffer_load_dwordx2 v[84:85], v14, s[16:19], s57 offen offset:1792 nt
  buffer_load_dwordx2 v[86:87], v14, s[16:19], s57 offen offset:2688 nt
  s_add_u32 s57, s57, 25088
  buffer_load_dwordx2 v[88:89], v14, s[16:19], s57 offen nt
  buffer_load_dwordx2 v[90:91], v14, s[16:19], s57 offen offset:896 nt
  buffer_load_dwordx2 v[92:93], v14, s[16:19], s57 offen offset:1792 nt
  buffer_load_dwordx2 v[94:95], v14, s[16:19], s57 offen offset:2688 nt
  s_add_u32 s57, s57, 3584
  buffer_load_dwordx2 v[96:97], v14, s[16:19], s57 offen nt
  buffer_load_dwordx2 v[98:99], v14, s[16:19], s57 offen offset:896 nt
  buffer_load_dwordx2 v[100:101], v14, s[16:19], s57 offen offset:1792 nt
  buffer_load_dwordx2 v[102:103], v14, s[16:19], s57 offen offset:2688 nt
  s_waitcnt vmcnt(32)
  v_perm_b32 v200, v170, v168, s62
  v_perm_b32 v201, v174, v172, s62
  v_perm_b32 v202, v178, v176, s62
  v_perm_b32 v203, v182, v180, s62
  v_perm_b32 v204, v170, v168, s63
  v_perm_b32 v205, v174, v172, s63
  v_perm_b32 v206, v178, v176, s63
  v_perm_b32 v207, v182, v180, s63
  v_perm_b32 v208, v171, v169, s62
  v_perm_b32 v209, v175, v173, s62
  v_perm_b32 v210, v179, v177, s62
  v_perm_b32 v211, v183, v181, s62
  v_perm_b32 v212, v171, v169, s63
  v_perm_b32 v213, v175, v173, s63
  v_perm_b32 v214, v179, v177, s63
  v_perm_b32 v215, v183, v181, s63
  v_mfma_f32_16x16x32_bf16 v[232:235], v[16:19], v[200:203], 0
  v_mfma_f32_16x16x32_bf16 v[236:239], v[16:19], v[204:207], 0
  v_mfma_f32_16x16x32_bf16 v[240:243], v[16:19], v[208:211], 0
  v_mfma_f32_16x16x32_bf16 v[244:247], v[16:19], v[212:215], 0
  v_perm_b32 v104, v42, v40, s62
  v_perm_b32 v105, v46, v44, s62
  v_perm_b32 v106, v50, v48, s62
  v_perm_b32 v107, v54, v52, s62
  v_perm_b32 v108, v42, v40, s63
  v_perm_b32 v109, v46, v44, s63
  v_perm_b32 v110, v50, v48, s63
  v_perm_b32 v111, v54, v52, s63
  v_perm_b32 v112, v43, v41, s62
  v_perm_b32 v113, v47, v45, s62
  v_perm_b32 v114, v51, v49, s62
  v_perm_b32 v115, v55, v53, s62
  v_perm_b32 v116, v43, v41, s63
  v_perm_b32 v117, v47, v45, s63
  v_perm_b32 v118, v51, v49, s63
  v_perm_b32 v119, v55, v53, s63
  s_waitcnt vmcnt(16)
  v_perm_b32 v216, v186, v184, s62
  v_perm_b32 v217, v190, v188, s62
  v_perm_b32 v218, v194, v192, s62
  v_perm_b32 v219, v198, v196, s62
  v_perm_b32 v220, v186, v184, s63
  v_perm_b32 v221, v190, v188, s63
  v_perm_b32 v222, v194, v192, s63
  v_perm_b32 v223, v198, v196, s63
  v_perm_b32 v224, v187, v185, s62
  v_perm_b32 v225, v191, v189, s62
  v_perm_b32 v226, v195, v193, s62
  v_perm_b32 v227, v199, v197, s62
  v_perm_b32 v228, v187, v185, s63
  v_perm_b32 v229, v191, v189, s63
  v_perm_b32 v230, v195, v193, s63
  v_perm_b32 v231, v199, v197, s63
  v_mfma_f32_16x16x32_bf16 v[168:171], v[16:19], v[216:219], 0
  v_mfma_f32_16x16x32_bf16 v[172:175], v[16:19], v[220:223], 0
  v_mfma_f32_16x16x32_bf16 v[176:179], v[16:19], v[224:227], 0
  v_mfma_f32_16x16x32_bf16 v[180:183], v[16:19], v[228:231], 0
  v_perm_b32 v120, v58, v56, s62
  v_perm_b32 v121, v62, v60, s62
  v_perm_b32 v122, v66, v64, s62
  v_perm_b32 v123, v70, v68, s62
  v_perm_b32 v124, v58, v56, s63
  v_perm_b32 v125, v62, v60, s63
  v_perm_b32 v126, v66, v64, s63
  v_perm_b32 v127, v70, v68, s63
  v_perm_b32 v128, v59, v57, s62
  v_perm_b32 v129, v63, v61, s62
  v_perm_b32 v130, v67, v65, s62
  v_perm_b32 v131, v71, v69, s62
  v_perm_b32 v132, v59, v57, s63
  v_perm_b32 v133, v63, v61, s63
  v_perm_b32 v134, v67, v65, s63
  v_perm_b32 v135, v71, v69, s63
  s_waitcnt vmcnt(8)
  v_perm_b32 v136, v74, v72, s62
  v_perm_b32 v137, v78, v76, s62
  v_perm_b32 v138, v82, v80, s62
  v_perm_b32 v139, v86, v84, s62
  v_perm_b32 v140, v74, v72, s63
  v_perm_b32 v141, v78, v76, s63
  v_perm_b32 v142, v82, v80, s63
  v_perm_b32 v143, v86, v84, s63
  v_perm_b32 v144, v75, v73, s62
  v_perm_b32 v145, v79, v77, s62
  v_perm_b32 v146, v83, v81, s62
  v_perm_b32 v147, v87, v85, s62
  v_perm_b32 v148, v75, v73, s63
  v_perm_b32 v149, v79, v77, s63
  v_perm_b32 v150, v83, v81, s63
  v_perm_b32 v151, v87, v85, s63
  s_waitcnt vmcnt(0)
  v_perm_b32 v152, v90, v88, s62
  v_perm_b32 v153, v94, v92, s62
  v_perm_b32 v154, v98, v96, s62
  v_perm_b32 v155, v102, v100, s62
  v_perm_b32 v156, v90, v88, s63
  v_perm_b32 v157, v94, v92, s63
  v_perm_b32 v158, v98, v96, s63
  v_perm_b32 v159, v102, v100, s63
  v_perm_b32 v160, v91, v89, s62
  v_perm_b32 v161, v95, v93, s62
  v_perm_b32 v162, v99, v97, s62
  v_perm_b32 v163, v103, v101, s62
  v_perm_b32 v164, v91, v89, s63
  v_perm_b32 v165, v95, v93, s63
  v_perm_b32 v166, v99, v97, s63
  v_perm_b32 v167, v103, v101, s63
  v_mov_b32 v233, v169
  v_mov_b32 v235, v171
  v_mov_b32 v237, v173
  v_mov_b32 v239, v175
  v_mov_b32 v241, v177
  v_mov_b32 v243, v179
  v_mov_b32 v245, v181
  v_mov_b32 v247, v183
  s_mov_b32 s72, 0
  s_cmp_eq_u32 s61, 0
  s_cbranch_scc1 L_nobar2
  s_barrier
L_nobar2:
  s_mov_b64 exec, s[64:65]
  buffer_load_dwordx4 v[20:23], v1, s[44:47], 0 offen sc1
  s_mov_b64 exec, s[66:67]
  buffer_load_dwordx4 v[24:27], v1, s[44:47], 0 offen offset:64 sc1
  s_mov_b64 exec, s[68:69]
  buffer_load_dwordx4 v[28:31], v1, s[44:47], 0 offen offset:128 sc1
  s_mov_b64 exec, s[70:71]
  buffer_load_dwordx4 v[32:35], v1, s[44:47], 0 offen offset:192 sc1
  s_mov_b64 exec, -1
  ds_read_b64 v[12:13], v10 offset:4704
  s_waitcnt lgkmcnt(0)
  v_mul_f32 v56, v12, v232
  v_mul_f32 v57, v12, v233
  v_mul_f32 v58, v13, v234
  v_mul_f32 v59, v13, v235
  v_mul_f32 v60, v12, v236
  v_mul_f32 v61, v12, v237
  v_mul_f32 v62, v13, v238
  v_mul_f32 v63, v13, v239
  v_mul_f32 v64, v12, v240
  v_mul_f32 v65, v12, v241
  v_mul_f32 v66, v13, v242
  v_mul_f32 v67, v13, v243
  v_mul_f32 v68, v12, v244
  v_mul_f32 v69, v12, v245
  v_mul_f32 v70, v13, v246
  v_mul_f32 v71, v13, v247
  s_nop 0
  s_branch L_pchk
L_ppoll:
  s_mov_b64 exec, s[64:65]
  buffer_load_dwordx4 v[20:23], v1, s[44:47], 0 offen sc1
  s_mov_b64 exec, s[66:67]
  buffer_load_dwordx4 v[24:27], v1, s[44:47], 0 offen offset:64 sc1
  s_mov_b64 exec, s[68:69]
  buffer_load_dwordx4 v[28:31], v1, s[44:47], 0 offen offset:128 sc1
  s_mov_b64 exec, s[70:71]
  buffer_load_dwordx4 v[32:35], v1, s[44:47], 0 offen offset:192 sc1
  s_mov_b64 exec, -1
L_pchk:
  s_add_u32 s72, s72, 1
  s_waitcnt vmcnt(0)
  s_mov_b64 exec, s[64:65]
  v_max3_u32 v8, v20, v21, v22
  v_max_u32 v8, v8, v23
  v_cmp_eq_u32_e64 s[64:65], -1, v8
  s_mov_b64 exec, s[66:67]
  v_max3_u32 v8, v24, v25, v26
  v_max_u32 v8, v8, v27
  v_cmp_eq_u32_e64 s[66:67], -1, v8
  s_mov_b64 exec, s[68:69]
  v_max3_u32 v8, v28, v29, v30
  v_max_u32 v8, v8, v31
  v_cmp_eq_u32_e64 s[68:69], -1, v8
  s_mov_b64 exec, s[70:71]
  v_max3_u32 v8, v32, v33, v34
  v_max_u32 v8, v8, v35
  v_cmp_eq_u32_e64 s[70:71], -1, v8
  s_mov_b64 exec, -1
  s_or_b64 s[74:75], s[64:65], s[66:67]
  s_or_b64 s[76:77], s[68:69], s[70:71]
  s_or_b64 s[74:75], s[74:75], s[76:77]
  s_cmp_gt_u32 s72, 20000
  s_cselect_b64 s[74:75], 0, s[74:75]
  s_cmp_lg_u64 s[74:75], 0
  s_cbranch_scc1 L_ppoll
  v_mfma_f32_16x16x32_bf16 v[56:59], v[20:23], v[104:107], v[56:59]
  v_mfma_f32_16x16x32_bf16 v[60:63], v[20:23], v[108:111], v[60:63]
  v_mfma_f32_16x16x32_bf16 v[64:67], v[20:23], v[112:115], v[64:67]
  v_mfma_f32_16x16x32_bf16 v[68:71], v[20:23], v[116:119], v[68:71]
  v_mfma_f32_16x16x32_bf16 v[56:59], v[24:27], v[120:123], v[56:59]
  v_mfma_f32_16x16x32_bf16 v[60:63], v[24:27], v[124:127], v[60:63]
  v_mfma_f32_16x16x32_bf16 v[64:67], v[24:27], v[128:131], v[64:67]
  v_mfma_f32_16x16x32_bf16 v[68:71], v[24:27], v[132:135], v[68:71]
  v_mfma_f32_16x16x32_bf16 v[56:59], v[28:31], v[136:139], v[56:59]
  v_mfma_f32_16x16x32_bf16 v[60:63], v[28:31], v[140:143], v[60:63]
  v_mfma_f32_16x16x32_bf16 v[64:67], v[28:31], v[144:147], v[64:67]
  v_mfma_f32_16x16x32_bf16 v[68:71], v[28:31], v[148:151], v[68:71]
  v_mfma_f32_16x16x32_bf16 v[56:59], v[32:35], v[152:155], v[56:59]
  v_mfma_f32_16x16x32_bf16 v[60:63], v[32:35], v[156:159], v[60:63]
  v_mfma_f32_16x16x32_bf16 v[64:67], v[32:35], v[160:163], v[64:67]
  v_mfma_f32_16x16x32_bf16 v[68:71], v[32:35], v[164:167], v[68:71]
  s_nop 4
  v_add_f32 v80, v56, v57
  v_add_f32 v81, v60, v61
  v_add_f32 v82, v64, v65
  v_add_f32 v83, v68, v69
  v_bfi_b32 v72, s5, v4, v80
  v_bfi_b32 v73, s5, v5, v81
  v_bfi_b32 v74, s5, v6, v82
  v_bfi_b32 v75, s5, v7, v83
  buffer_store_dwordx4 v[72:75], v9, s[48:51], s78 offen
  v_add_f32 v80, v58, v59
  v_add_f32 v81, v62, v63
  v_add_f32 v82, v66, v67
  v_add_f32 v83, v70, v71
  v_bfi_b32 v76, s5, v4, v80
  v_bfi_b32 v77, s5, v5, v81
  v_bfi_b32 v78, s5, v6, v82
  v_bfi_b32 v79, s5, v7, v83
  buffer_store_dwordx4 v[76:79], v9, s[48:51], s79 offen
  buffer_store_dwordx4 v[72:75], v9, s[48:51], 0 offen sc1
  buffer_store_dwordx4 v[76:79], v9, s[48:51], s59 offen sc1
  s_cmp_eq_u32 s61, 1
  s_cbranch_scc1 L_w4_bar
  s_mov_b32 s61, 1
  s_mov_b32 s50, 1450240
  s_mov_b32 s18, 113920
  s_cmp_lt_u32 s37, 28
  s_cselect_b32 s26, 56576, 0
  v_not_b32 v72, v4
  v_not_b32 v73, v5
  v_not_b32 v74, v6
  v_not_b32 v75, v7
  buffer_store_dwordx4 v[72:75], v9, s[48:51], s78 offen
  buffer_store_dwordx4 v[72:75], v9, s[48:51], s79 offen
  s_getreg_b32 s56, hwreg(HW_REG_XCC_ID, 0, 3)
  s_lshl_b32 s60, s56, 8
  s_xnor_b32 s60, s60, s4
  s_lshl_b32 s58, s34, 7
  s_lshl2_add_u32 s58, s37, s58
  s_add_u32 s58, s58, 0x4000
  v_mov_b32 v80, s58
  v_mov_b32 v81, s60
  s_mov_b64 exec, 1
  global_store_dword v80, v81, s[32:33]
  s_mov_b64 exec, -1
  s_mov_b64 s[64:65], -1
  s_mov_b64 s[66:67], -1
  s_mov_b64 s[68:69], -1
  s_mov_b64 s[70:71], -1
  s_lshl_b32 s56, s56, 13
  s_add_u32 s56, s56, 73216
  v_and_b32 v20, 31, v0
  v_lshlrev_b32 v20, 2, v20
  v_add_u32 v20, s56, v20
  s_lshr_b32 s58, s2, 3
  s_lshl_b32 s74, 1, s58
  s_mov_b32 s75, 0
  v_mov_b32 v21, 0
  s_mov_b32 s72, 0
  s_mov_b32 s73, 0
L_tw:
  ds_read_b128 v[24:27], v21 offset:4672
  s_add_u32 s72, s72, 1
  s_cmp_gt_u32 s72, 160000
  s_cbranch_scc1 L_tgo
  s_waitcnt lgkmcnt(0)
  v_min_u32 v24, v24, v25
  v_min3_u32 v24, v24, v26, v27
  s_nop 0
  v_readfirstlane_b32 s58, v24
  s_cmp_lt_u32 s58, 903168
  s_nop 2
  s_cbranch_scc1 L_tw
  s_branch L_tgo
  s_cmp_lt_u32 s58, 870912
  s_cbranch_scc1 L_tw
  s_cmp_lt_u32 s58, 903168
  s_cbranch_scc1 L_tl
  s_add_u32 s73, s73, 1
  s_cmp_gt_u32 s73, 4
  s_cbranch_scc1 L_tgo
  s_mov_b64 exec, s[74:75]
  global_store_dword v20, v4, s[32:33]
  s_mov_b64 exec, -1
  s_mov_b32 s74, 0
L_tl:
  global_load_dword v22, v20, s[32:33] nt
  s_waitcnt vmcnt(0)
  v_cmp_eq_u32 vcc, v22, v4
  s_bcnt1_i32_b32 s58, vcc_lo
  s_cmp_lt_u32 s58, 12
  s_nop 1
  s_cbranch_scc1 L_tw
L_tgo:
  s_waitcnt lgkmcnt(0)
  s_branch L_proj
L_w4_bar:
  s_barrier
  s_endpgm
L_w4_done:
  s_endpgm
L_w5:
  v_mov_b32 v8, -1
  v_mov_b32 v9, -1
  v_mov_b32 v10, -1
  v_mov_b32 v11, -1
  v_mov_b32 v12, 0
  ds_write_b128 v12, v[8:11] offset:4608
  ds_write_b128 v12, v[8:11] offset:4624
  ds_write_b128 v12, v[8:11] offset:4640
  ds_write_b32 v12, v12 offset:4656
  ds_write_b32 v12, v12 offset:512
  v_mov_b32 v13, 0
  v_mov_b32 v14, 0
  v_mov_b32 v15, 0
  ds_write_b128 v12, v[12:15] offset:4672
  ds_write_b128 v12, v[12:15] offset:4688
  s_lshl_b32 s59, s35, 13
  s_lshl_b32 s60, s39, 9
  s_add_u32 s59, s59, s60
  s_add_u32 s59, s59, 131072
  s_lshl_b32 s58, s34, 15
  s_lshl_b32 s60, s35, 11
  s_add_u32 s58, s58, s60
  s_add_u32 s58, s58, 524288
  v_lshlrev_b32 v1, 4, v0
  v_lshlrev_b32 v13, 3, v0
  s_mul_i32 s57, s34, 896
  s_waitcnt lgkmcnt(0)
  s_add_u32 s32, s32, 0x3fc00000
  s_addc_u32 s33, s33, 0
  s_load_dword s4, s[32:33], 0
  s_add_u32 s48, s32, s59
  s_addc_u32 s49, s33, 0
  s_mov_b32 s50, 512
  s_mov_b32 s51, 0x20000
  buffer_store_dwordx2 v[8:9], v13, s[48:51], 0 offen sc1
  s_add_u32 s40, s32, s58
  s_addc_u32 s41, s33, 0
  s_mov_b32 s42, 2048
  s_mov_b32 s43, 0x20000
  s_add_u32 s44, s8, s57
  s_addc_u32 s45, s9, 0
  s_mov_b32 s46, 896
  s_mov_b32 s47, 0x20000
  s_mov_b32 s48, s26
  s_mov_b32 s49, s27
  s_mov_b32 s50, 896
  s_mov_b32 s51, 0x20000
  buffer_load_dwordx4 v[40:43], v1, s[44:47], 0 offen
  buffer_load_dwordx4 v[44:47], v1, s[48:51], 0 offen
  s_mov_b64 s[64:65], -1
  s_mov_b64 s[66:67], -1
  s_mov_b32 s54, 0
  s_waitcnt lgkmcnt(0)
  s_add_u32 s4, s4, 0x01010101
  s_mov_b32 s5, 0xff
  s_mov_b32 s6, 0x0c0c0400
  s_mov_b32 s7, 0x04000c0c
  v_mov_b32 v4, s4
  v_mov_b32 v11, 0x80
  v_lshrrev_b32 v5, 8, v4
  v_lshrrev_b32 v6, 16, v4
  v_lshrrev_b32 v7, 24, v4
  s_waitcnt vmcnt(0)
  s_mov_b32 s72, 0
L_qwait:
  ds_read_b32 v16, v12 offset:512
  s_add_u32 s72, s72, 1
  s_cmp_gt_u32 s72, 400
  s_cbranch_scc1 L_qwait_x
  s_waitcnt lgkmcnt(0)
  v_readfirstlane_b32 s56, v16
  s_cmp_lg_u32 s56, 0xff800000
  s_nop 2
  s_cbranch_scc1 L_qwait
L_qwait_x:
  s_waitcnt lgkmcnt(0)
L_qpoll:
  s_mov_b64 exec, s[64:65]
  buffer_load_dwordx4 v[16:19], v1, s[40:43], 0 offen sc1
  s_mov_b64 exec, s[66:67]
  buffer_load_dwordx4 v[20:23], v1, s[40:43], 0 offen offset:1024 sc1
  s_add_u32 s54, s54, 1
  s_waitcnt vmcnt(0)
  s_mov_b64 exec, s[64:65]
  v_perm_b32 v8, v17, v16, s6
  v_perm_b32 v9, v19, v18, s7
  v_or_b32 v8, v8, v9
  v_cmp_ne_u32_e64 s[64:65], v8, v4
  s_wqm_b64 s[64:65], s[64:65]
  s_mov_b64 exec, s[66:67]
  v_perm_b32 v8, v21, v20, s6
  v_perm_b32 v9, v23, v22, s7
  v_or_b32 v8, v8, v9
  v_cmp_ne_u32_e64 s[66:67], v8, v4
  s_wqm_b64 s[66:67], s[66:67]
  s_mov_b64 exec, -1
  s_or_b64 s[80:81], s[64:65], s[66:67]
  s_cmp_gt_u32 s54, 20000
  s_cselect_b64 s[80:81], 0, s[80:81]
  s_cmp_lg_u64 s[80:81], 0
  s_cbranch_scc1 L_qpoll
  v_bfi_b32 v16, s5, v11, v16
  v_bfi_b32 v17, s5, v11, v17
  v_bfi_b32 v18, s5, v11, v18
  v_bfi_b32 v19, s5, v11, v19
  v_bfi_b32 v20, s5, v11, v20
  v_bfi_b32 v21, s5, v11, v21
  v_bfi_b32 v22, s5, v11, v22
  v_bfi_b32 v23, s5, v11, v23
  v_add_f32 v16, v16, v20
  v_add_f32 v17, v17, v21
  v_add_f32 v18, v18, v22
  v_add_f32 v19, v19, v23
  v_cvt_pk_bf16_f32 v16, v16, v17
  v_cvt_pk_bf16_f32 v17, v18, v19
  ds_write_b64 v13, v[16:17] offset:0
  s_waitcnt lgkmcnt(0)
  s_barrier
  v_lshlrev_b32 v16, 16, v40
  v_and_b32 v17, 0xffff0000, v40
  v_lshlrev_b32 v24, 16, v44
  v_and_b32 v25, 0xffff0000, v44
  v_lshlrev_b32 v18, 16, v41
  v_and_b32 v19, 0xffff0000, v41
  v_lshlrev_b32 v26, 16, v45
  v_and_b32 v27, 0xffff0000, v45
  v_lshlrev_b32 v20, 16, v42
  v_and_b32 v21, 0xffff0000, v42
  v_lshlrev_b32 v28, 16, v46
  v_and_b32 v29, 0xffff0000, v46
  v_lshlrev_b32 v22, 16, v43
  v_and_b32 v23, 0xffff0000, v43
  v_lshlrev_b32 v30, 16, v47
  v_and_b32 v31, 0xffff0000, v47
  v_mul_f32 v16, v16, v24
  v_mul_f32 v17, v17, v25
  v_mul_f32 v18, v18, v26
  v_mul_f32 v19, v19, v27
  v_mul_f32 v20, v20, v28
  v_mul_f32 v21, v21, v29
  v_mul_f32 v22, v22, v30
  v_mul_f32 v23, v23, v31
  v_cvt_pk_bf16_f32 v24, v16, v17
  v_cvt_pk_bf16_f32 v25, v18, v19
  v_cvt_pk_bf16_f32 v26, v20, v21
  v_cvt_pk_bf16_f32 v27, v22, v23
  v_lshlrev_b32 v16, 16, v24
  v_and_b32 v17, 0xffff0000, v24
  v_lshlrev_b32 v18, 16, v25
  v_and_b32 v19, 0xffff0000, v25
  v_lshlrev_b32 v20, 16, v26
  v_and_b32 v21, 0xffff0000, v26
  v_lshlrev_b32 v22, 16, v27
  v_and_b32 v23, 0xffff0000, v27
  v_add_f32 v16, v16, v17
  v_add_f32 v16, v16, v18
  v_add_f32 v16, v16, v19
  v_add_f32 v16, v16, v20
  v_add_f32 v16, v16, v21
  v_add_f32 v16, v16, v22
  v_add_f32 v16, v16, v23
  s_nop 1
  v_add_f32_dpp v16, v16, v16 row_ror:8 row_mask:0xf bank_mask:0xf
  s_nop 1
  v_add_f32_dpp v16, v16, v16 row_ror:4 row_mask:0xf bank_mask:0xf
  s_nop 1
  v_add_f32_dpp v16, v16, v16 row_ror:2 row_mask:0xf bank_mask:0xf
  s_nop 1
  v_add_f32_dpp v16, v16, v16 row_ror:1 row_mask:0xf bank_mask:0xf
  v_mov_b32 v17, v16
  s_nop 1
  v_permlane16_swap_b32 v16, v17
  v_add_f32 v16, v16, v17
  v_mov_b32 v17, v16
  s_nop 1
  v_permlane32_swap_b32 v16, v17
  v_add_f32 v16, v16, v17
  v_cvt_pk_bf16_f32 v24, v16, v17
  v_lshlrev_b32 v16, 16, v24
  v_and_b32 v17, 0xffff0000, v24
  v_mul_f32 v16, 0xbfb8aa3b, v16
  v_exp_f32 v16, v16
  s_nop 0
  v_add_f32 v16, 1.0, v16
  v_rcp_f32 v16, v16
  s_nop 0
  v_cvt_pk_bf16_f32 v24, v16, v17
  v_lshlrev_b32 v16, 16, v24
  v_and_b32 v17, 0xffff0000, v24
  v_sub_f32 v18, 1.0, v16
  v_cvt_pk_bf16_f32 v24, v18, v19
  v_lshlrev_b32 v18, 16, v24
  v_and_b32 v19, 0xffff0000, v24
  v_mov_b32 v60, v16
  v_lshrrev_b32 v61, 16, v18
  s_lshl_b32 s58, s35, 8
  s_add_u32 s58, s58, 4096
  s_mov_b32 s40, s32
  s_mov_b32 s41, s33
  s_mov_b32 s42, 65536
  s_mov_b32 s43, 0x20000
  s_lshr_b32 s66, s2, 4
  s_lshl_b32 s67, s66, 8
  s_add_u32 s67, s67, 4096
  s_mov_b32 s66, s58
  s_lshl_b32 s57, s39, 4
  s_add_u32 s57, s57, s58
  s_mov_b32 s61, 0x3db8aa3b
  s_mov_b32 s72, 0
L_pollml:
  ds_read_b128 v[16:19], v12 offset:4608
  ds_read_b128 v[20:23], v12 offset:4624
  s_add_u32 s72, s72, 1
  s_cmp_gt_u32 s72, 160000
  s_cbranch_scc1 L_pollml_x
  s_waitcnt lgkmcnt(0)
  v_max3_u32 v24, v16, v17, v18
  v_max3_u32 v24, v24, v19, v20
  v_max3_u32 v24, v24, v21, v22
  v_max_u32 v24, v24, v23
  s_nop 0
  v_readfirstlane_b32 s56, v24
  s_cmp_eq_u32 s56, -1
  s_nop 2
  s_cbranch_scc1 L_pollml
L_pollml_x:
  s_waitcnt lgkmcnt(0)
  v_max_f32 v24, v16, v17
  v_max3_f32 v24, v24, v18, v19
  v_sub_f32 v28, v16, v24
  v_sub_f32 v29, v17, v24
  v_sub_f32 v30, v18, v24
  v_sub_f32 v31, v19, v24
  v_mul_f32 v28, s61, v28
  v_mul_f32 v29, s61, v29
  v_mul_f32 v30, s61, v30
  v_mul_f32 v31, s61, v31
  v_exp_f32 v28, v28
  v_exp_f32 v29, v29
  v_exp_f32 v30, v30
  v_exp_f32 v31, v31
  v_mul_f32 v25, v28, v20
  v_fmac_f32 v25, v29, v21
  v_fmac_f32 v25, v30, v22
  v_fmac_f32 v25, v31, v23
  v_or_b32 v32, v24, v61
  v_mov_b32 v33, v25
  v_mov_b32 v34, v4
  v_mov_b32 v35, v4
  s_mov_b64 exec, 1
  buffer_store_dwordx4 v[32:35], v12, s[40:43], s57 offen sc1
  s_mov_b64 exec, -1
  v_lshlrev_b32 v14, 4, v2
  v_mov_b32 v8, s66
  v_mov_b32 v9, s67
  v_cmp_gt_u32 vcc, 16, v0
  s_nop 1
  v_cndmask_b32 v8, v9, v8, vcc
  v_add_u32 v14, v14, v8
  v_lshrrev_b32 v15, 1, v2
  v_lshlrev_b32 v15, 2, v15
  s_mov_b32 s72, 0
  s_nop 0
L_rwait:
  ds_read_b32 v8, v12 offset:4672
  s_add_u32 s72, s72, 1
  s_cmp_gt_u32 s72, 20000
  s_cbranch_scc1 L_rwait_x
  s_waitcnt lgkmcnt(0)
  v_readfirstlane_b32 s56, v8
  s_cmp_lt_u32 s56, 612864
  s_nop 2
  s_cbranch_scc1 L_rwait
L_rwait_x:
  s_waitcnt lgkmcnt(0)
  s_mov_b32 s72, 0
  s_mov_b32 s64, -1
  s_mov_b32 s65, 0
  s_mov_b64 exec, s[64:65]
  buffer_load_dwordx4 v[36:39], v14, s[40:43], 0 offen
  s_branch L_recpoll_w
L_recpoll:
  s_mov_b64 exec, s[64:65]
  buffer_load_dwordx4 v[36:39], v14, s[40:43], 0 offen sc1
L_recpoll_w:
  s_add_u32 s72, s72, 1
  s_waitcnt vmcnt(0)
  v_xor_b32 v8, v38, v4
  v_xor_b32 v9, v39, v4
  v_or_b32 v8, v8, v9
  v_cmp_ne_u32_e64 s[64:65], 0, v8
  s_mov_b64 exec, -1
  s_cmp_gt_u32 s72, 20000
  s_cselect_b64 s[64:65], 0, s[64:65]
  s_cmp_lg_u64 s[64:65], 0
  s_cbranch_scc1 L_recpoll
  s_xor_b32 s56, s39, 1
  v_readlane_b32 s58, v36, s56
  v_readlane_b32 s59, v37, s56
  v_lshlrev_b32 v8, 16, v36
  s_mov_b64 exec, 0xffff
  ds_write_b32 v15, v8 offset:4704
  s_mov_b64 exec, -1
  s_and_b32 s58, s58, 0xffff0000
  v_max_f32 v26, s58, v24
  v_sub_f32 v27, s58, v26
  v_sub_f32 v24, v24, v26
  v_mul_f32 v27, s61, v27
  v_mul_f32 v24, s61, v24
  v_exp_f32 v27, v27
  v_exp_f32 v24, v24
  v_mul_f32 v27, s59, v27
  v_fmac_f32 v27, v24, v33
  v_rcp_f32 v27, v27
  s_nop 0
  v_mul_f32 v27, v27, v24
  v_mul_f32 v27, v60, v27
  v_mul_f32 v28, v27, v28
  v_mul_f32 v29, v27, v29
  v_mul_f32 v30, v27, v30
  v_mul_f32 v31, v27, v31
  v_min_u32 v28, -2, v28
  v_min_u32 v29, -2, v29
  v_min_u32 v30, -2, v30
  v_min_u32 v31, -2, v31
  ds_write_b128 v12, v[28:31] offset:4640
  s_waitcnt lgkmcnt(0)
  s_bfe_u32 s34, s2, 0x30003
  s_and_b32 s37, s2, 7
  s_lshl_b32 s37, s37, 1
  s_lshr_b32 s58, s2, 6
  s_cmp_gt_u32 s58, 1
  s_cselect_b32 s58, 16, s58
  s_add_u32 s37, s37, s58
  s_cmp_lt_u32 s37, 14
  s_cbranch_scc1 L_fin
  s_endpgm
L_fin:
  s_mul_i32 s58, s34, 57344
  s_add_u32 s58, s58, 1048576
  s_add_u32 s40, s32, s58
  s_addc_u32 s41, s33, 0
  s_mov_b32 s42, 57344
  s_mov_b32 s43, 0x20000
  s_add_u32 s58, s58, 0x100000
  s_add_u32 s48, s32, s58
  s_addc_u32 s49, s33, 0
  s_mov_b32 s50, 57344
  s_mov_b32 s51, 0x20000
  v_lshrrev_b32 v16, 3, v0
  v_mul_u32_u24 v1, 1792, v16
  v_and_b32 v16, 7, v0
  v_lshlrev_b32 v16, 4, v16
  v_add_u32 v1, v1, v16
  s_lshl_b32 s59, s37, 7
  v_add_u32 v1, s59, v1
  s_mov_b32 s76, 14336
  s_mov_b32 s77, 28672
  s_mov_b32 s78, 43008
  s_mul_i32 s59, s34, 896
  s_add_u32 s44, s28, s59
  s_addc_u32 s45, s29, 0
  s_mov_b32 s46, 0
  s_mov_b32 s47, 0x20000
  s_lshl_b32 s59, s37, 6
  v_add_u32 v13, s59, v13
  v_cmp_gt_u32 vcc, 8, v0
  v_mov_b32 v16, 0x40000000
  s_nop 0
  v_cndmask_b32 v13, v16, v13, vcc
  v_and_b32 v17, 31, v0
  v_lshlrev_b32 v17, 2, v17
  s_and_b32 s59, s2, 7
  s_lshl_b32 s59, s59, 7
  s_add_u32 s59, s59, 0x4000
  v_add_u32 v17, s59, v17
  global_load_dword v18, v17, s[32:33] nt
  s_getreg_b32 s60, hwreg(HW_REG_XCC_ID, 0, 3)
  s_lshl_b32 s60, s60, 8
  s_xnor_b32 s60, s60, s4
  s_waitcnt vmcnt(0)
  v_cmp_ne_u32 vcc, s60, v18
  s_mov_b32 s55, vcc_lo
  s_mov_b32 s61, 0
  s_mov_b64 s[64:65], 0
  s_mov_b64 s[66:67], 0
  s_mov_b64 s[68:69], 0
  s_mov_b64 s[70:71], 0
L_gather:
  s_mov_b32 s54, 0
  s_cmp_lg_u32 s55, 0
  s_cbranch_scc1 L_gpoll
L_gpolla:
  s_mov_b64 exec, s[64:65]
  buffer_load_dwordx4 v[16:19], v1, s[48:51], 0 offen nt
  s_mov_b64 exec, s[66:67]
  buffer_load_dwordx4 v[20:23], v1, s[48:51], s76 offen nt
  s_mov_b64 exec, s[68:69]
  buffer_load_dwordx4 v[24:27], v1, s[48:51], s77 offen nt
  s_mov_b64 exec, s[70:71]
  buffer_load_dwordx4 v[28:31], v1, s[48:51], s78 offen nt
  s_add_u32 s54, s54, 1
  s_waitcnt vmcnt(0)
  s_mov_b64 exec, s[64:65]
  v_perm_b32 v8, v17, v16, s6
  v_perm_b32 v9, v19, v18, s7
  v_or_b32 v8, v8, v9
  v_cmp_ne_u32_e64 s[64:65], v8, v4
  s_wqm_b64 s[64:65], s[64:65]
  s_mov_b64 exec, s[66:67]
  v_perm_b32 v8, v21, v20, s6
  v_perm_b32 v9, v23, v22, s7
  v_or_b32 v8, v8, v9
  v_cmp_ne_u32_e64 s[66:67], v8, v4
  s_wqm_b64 s[66:67], s[66:67]
  s_mov_b64 exec, s[68:69]
  v_perm_b32 v8, v25, v24, s6
  v_perm_b32 v9, v27, v26, s7
  v_or_b32 v8, v8, v9
  v_cmp_ne_u32_e64 s[68:69], v8, v4
  s_wqm_b64 s[68:69], s[68:69]
  s_mov_b64 exec, s[70:71]
  v_perm_b32 v8, v29, v28, s6
  v_perm_b32 v9, v31, v30, s7
  v_or_b32 v8, v8, v9
  v_cmp_ne_u32_e64 s[70:71], v8, v4
  s_wqm_b64 s[70:71], s[70:71]
  s_mov_b64 exec, -1
  s_or_b64 s[80:81], s[64:65], s[66:67]
  s_or_b64 s[80:81], s[80:81], s[68:69]
  s_or_b64 s[80:81], s[80:81], s[70:71]
  s_cmp_gt_u32 s54, 40
  s_cselect_b64 s[80:81], 0, s[80:81]
  s_cmp_lg_u64 s[80:81], 0
  s_cbranch_scc1 L_gpolla
  s_cmp_le_u32 s54, 40
  s_cbranch_scc1 L_gok
L_gpoll:
  s_mov_b64 exec, s[64:65]
  buffer_load_dwordx4 v[16:19], v1, s[40:43], 0 offen sc1
  s_mov_b64 exec, s[66:67]
  buffer_load_dwordx4 v[20:23], v1, s[40:43], s76 offen sc1
  s_mov_b64 exec, s[68:69]
  buffer_load_dwordx4 v[24:27], v1, s[40:43], s77 offen sc1
  s_mov_b64 exec, s[70:71]
  buffer_load_dwordx4 v[28:31], v1, s[40:43], s78 offen sc1
  s_add_u32 s54, s54, 1
  s_waitcnt vmcnt(0)
  s_mov_b64 exec, s[64:65]
  v_perm_b32 v8, v17, v16, s6
  v_perm_b32 v9, v19, v18, s7
  v_or_b32 v8, v8, v9
  v_cmp_ne_u32_e64 s[64:65], v8, v4
  s_wqm_b64 s[64:65], s[64:65]
  s_mov_b64 exec, s[66:67]
  v_perm_b32 v8, v21, v20, s6
  v_perm_b32 v9, v23, v22, s7
  v_or_b32 v8, v8, v9
  v_cmp_ne_u32_e64 s[66:67], v8, v4
  s_wqm_b64 s[66:67], s[66:67]
  s_mov_b64 exec, s[68:69]
  v_perm_b32 v8, v25, v24, s6
  v_perm_b32 v9, v27, v26, s7
  v_or_b32 v8, v8, v9
  v_cmp_ne_u32_e64 s[68:69], v8, v4
  s_wqm_b64 s[68:69], s[68:69]
  s_mov_b64 exec, s[70:71]
  v_perm_b32 v8, v29, v28, s6
  v_perm_b32 v9, v31, v30, s7
  v_or_b32 v8, v8, v9
  v_cmp_ne_u32_e64 s[70:71], v8, v4
  s_wqm_b64 s[70:71], s[70:71]
  s_mov_b64 exec, -1
  s_or_b64 s[80:81], s[64:65], s[66:67]
  s_or_b64 s[80:81], s[80:81], s[68:69]
  s_or_b64 s[80:81], s[80:81], s[70:71]
  s_cmp_gt_u32 s54, 20000
  s_cselect_b64 s[80:81], 0, s[80:81]
  s_cmp_lg_u64 s[80:81], 0
  s_cbranch_scc1 L_gpoll
L_gok:
  v_bfi_b32 v16, s5, v11, v16
  v_bfi_b32 v17, s5, v11, v17
  v_bfi_b32 v18, s5, v11, v18
  v_bfi_b32 v19, s5, v11, v19
  v_bfi_b32 v20, s5, v11, v20
  v_bfi_b32 v21, s5, v11, v21
  v_bfi_b32 v22, s5, v11, v22
  v_bfi_b32 v23, s5, v11, v23
  v_bfi_b32 v24, s5, v11, v24
  v_bfi_b32 v25, s5, v11, v25
  v_bfi_b32 v26, s5, v11, v26
  v_bfi_b32 v27, s5, v11, v27
  v_bfi_b32 v28, s5, v11, v28
  v_bfi_b32 v29, s5, v11, v29
  v_bfi_b32 v30, s5, v11, v30
  v_bfi_b32 v31, s5, v11, v31
  v_add_f32 v16, v16, v20
  v_add_f32 v17, v17, v21
  v_add_f32 v18, v18, v22
  v_add_f32 v19, v19, v23
  v_add_f32 v24, v24, v28
  v_add_f32 v25, v25, v29
  v_add_f32 v26, v26, v30
  v_add_f32 v27, v27, v31
  v_add_f32 v48, v16, v24
  v_add_f32 v49, v17, v25
  v_add_f32 v50, v18, v26
  v_add_f32 v51, v19, v27
  v_add_f32_dpp v48, v48, v48 row_ror:8 row_mask:0xf bank_mask:0xf
  v_add_f32_dpp v49, v49, v49 row_ror:8 row_mask:0xf bank_mask:0xf
  v_add_f32_dpp v50, v50, v50 row_ror:8 row_mask:0xf bank_mask:0xf
  v_add_f32_dpp v51, v51, v51 row_ror:8 row_mask:0xf bank_mask:0xf
  v_mov_b32 v52, v48
  v_mov_b32 v53, v49
  v_mov_b32 v54, v50
  v_mov_b32 v55, v51
  v_permlane16_swap_b32 v48, v52
  v_permlane16_swap_b32 v49, v53
  v_permlane16_swap_b32 v50, v54
  v_permlane16_swap_b32 v51, v55
  v_add_f32 v48, v48, v52
  v_add_f32 v49, v49, v53
  v_add_f32 v50, v50, v54
  v_add_f32 v51, v51, v55
  v_mov_b32 v52, v48
  v_mov_b32 v53, v49
  v_mov_b32 v54, v50
  v_mov_b32 v55, v51
  v_permlane32_swap_b32 v48, v52
  v_permlane32_swap_b32 v49, v53
  v_permlane32_swap_b32 v50, v54
  v_permlane32_swap_b32 v51, v55
  v_add_f32 v48, v48, v52
  v_add_f32 v49, v49, v53
  v_add_f32 v50, v50, v54
  v_add_f32 v51, v51, v55
  v_cvt_pk_bf16_f32 v52, v48, v49
  v_cvt_pk_bf16_f32 v53, v50, v51
  buffer_store_dwordx2 v[52:53], v13, s[44:47], 0 offen
  s_cmp_eq_u32 s61, 1
  s_cbranch_scc1 L_fin_done
  s_mov_b32 s61, 1
  s_mov_b32 s46, 896
  s_mov_b64 s[64:65], -1
  s_mov_b64 s[66:67], -1
  s_mov_b64 s[68:69], -1
  s_mov_b64 s[70:71], -1
  s_barrier
  s_barrier
  s_branch L_gather
L_fin_done:
  s_cmp_lg_u32 s2, 0
  s_cbranch_scc1 L_noep
  s_mov_b64 exec, 1
  global_store_dword v12, v4, s[32:33] offset:0
  s_mov_b64 exec, -1
L_noep:
  s_endpgm
L_w7:
  v_mov_b32 v1, 0
  s_getreg_b32 s67, hwreg(HW_REG_XCC_ID, 0, 3)
  s_mov_b32 s57, 0
  s_mov_b32 s58, 0
  s_mov_b32 s72, 0
  s_mov_b32 s68, 0
  s_lshl_b32 s60, s67, 2
  s_lshr_b32 s66, 0xd3d3d3d3, s60
  s_bfe_i32 s66, s66, 0x40000
  s_lshl_b32 s59, s67, 13
  s_add_u32 s59, s59, 65536
  s_lshr_b32 s60, s2, 3
  v_lshlrev_b32 v13, 2, v0
  v_add_u32 v8, s59, v13
  s_lshl_b32 s61, s60, 8
  v_add_u32 v9, s61, v8
  s_lshl_b32 s62, 1, s60
  s_mov_b32 s63, 0
  v_lshlrev_b32 v12, 8, v0
  s_add_u32 s59, s59, 384
  v_add_u32 v12, s59, v12
  v_and_b32 v10, 1, v0
  v_lshlrev_b32 v10, 12, v10
  s_lshl_b32 s60, s67, 2
  s_add_u32 s60, s60, 0x2000
  v_add_u32 v10, s60, v10
  s_and_b32 s60, s67, 1
  s_lshl_b32 s60, s60, 12
  s_add_u32 s60, s60, 0x2000
  v_add_u32 v11, s60, v13
  s_lshl_b32 s64, 1, s67
  s_xor_b32 s64, s64, 0xff
  s_mov_b32 s65, 0
  s_waitcnt lgkmcnt(0)
  s_add_u32 s32, s32, 0x3fc00000
  s_addc_u32 s33, s33, 0
  s_load_dword s4, s[32:33], 0
  global_store_dword v9, v1, s[32:33]
  s_waitcnt lgkmcnt(0)
  s_add_u32 s4, s4, 0x01010101
  s_or_b32 s4, s4, 0x100
  s_andn2_b32 s4, s4, 0xff
  v_mov_b32 v3, s4
  s_barrier
  s_nop 0
L_w7poll:
  ds_read_b128 v[4:7], v1 offset:4672
  s_add_u32 s72, s72, 1
  s_cmp_gt_u32 s72, 160000
  s_cbranch_scc1 L_end
  s_waitcnt lgkmcnt(0)
  v_min_u32 v4, v4, v5
  v_min3_u32 v4, v4, v6, v7
  s_nop 0
  v_readfirstlane_b32 s59, v4
  s_cmp_lt_u32 s59, s57
  s_nop 2
  s_cbranch_scc1 L_w7poll
  s_mov_b64 exec, s[62:63]
  global_store_dword v8, v3, s[32:33]
  s_mov_b64 exec, -1
  global_load_dword v2, v8, s[32:33]
  s_add_u32 s57, s57, 32256
  s_and_b32 s60, s58, 3
  s_add_u32 s60, s60, s66
  s_ashr_i32 s60, s60, 2
  s_waitcnt vmcnt(0)
  v_cmp_eq_u32 vcc, v2, v3
  v_readlane_b32 s61, v2, 32
  v_add_u32 v8, 0x100, v8
  s_andn2_b32 s59, vcc_lo, s62
  s_bcnt1_i32_b32 s59, s59
  s_sub_u32 s61, s61, s4
  s_cmp_lt_u32 s61, 0x40
  s_cselect_b32 s68, s61, s68
  s_cmp_eq_u32 s68, 0
  s_cselect_b32 s61, 32, s68
  s_add_u32 s60, s60, s61
  s_add_u32 s60, s60, s59
  v_mov_b32 v4, s60
  v_mov_b32 v5, s60
  v_mov_b32 v6, s60
  v_mov_b32 v7, s60
  ds_write_b128 v1, v[4:7] offset:4688
  s_and_b32 s60, s58, 1
  s_lshl_b32 s60, s60, 8
  s_or_b32 s60, s60, s59
  s_cmp_lg_u32 s60, 272
  s_cbranch_scc1 L_w7n
  s_mov_b64 exec, 3
  global_store_dword v10, v3, s[32:33] sc1
  s_mov_b64 exec, s[64:65]
  global_load_dword v2, v11, s[32:33] sc1
  s_waitcnt vmcnt(0)
  v_cmp_eq_u32 vcc, v2, v3
  s_mov_b64 exec, 3
  s_bcnt1_i32_b64 s59, vcc
  s_lshl_b32 s59, s59, 2
  s_lshr_b32 s59, 0x7531fdb9, s59
  s_bfe_i32 s59, s59, 0x40000
  s_add_u32 s59, s59, 32
  s_add_u32 s59, s59, s4
  v_mov_b32 v2, s59
  global_store_dword v12, v2, s[32:33]
  s_mov_b64 exec, -1
L_w7n:
  v_add_u32 v10, 0x80, v10
  v_add_u32 v11, 0x80, v11
  v_add_u32 v12, 0x100, v12
  s_add_u32 s58, s58, 1
  s_cmp_lt_u32 s58, 28
  s_cbranch_scc1 L_w7poll
  s_waitcnt lgkmcnt(0)
L_end:
  s_endpgm
.section .rodata,"a"
.p2align 6
.amdhsa_kernel gated_mix__mha_block_cached__swiglu_ffn__decode_kernel
  .amdhsa_next_free_vgpr 256
  .amdhsa_next_free_sgpr 102
  .amdhsa_accum_offset 256
  .amdhsa_group_segment_fixed_size 0
  .amdhsa_kernarg_size 104
  .amdhsa_user_sgpr_count 2
  .amdhsa_user_sgpr_kernarg_segment_ptr 1
  .amdhsa_system_sgpr_workgroup_id_x 1
.end_amdhsa_kernel
```
